```python
import torch

def _softmax(x, axis=-1):
    return torch.softmax(x, dim=axis)

def _gelu(x):
    return torch.nn.functional.gelu(x, approximate='tanh')

def _silu(x):
    return torch.nn.functional.silu(x)

def _sigmoid(x):
    return torch.sigmoid(x)

def _layernorm(x, axis=-1, eps=1e-05):
    m = x.mean(dim=axis, keepdim=True)
    v = x.var(dim=axis, keepdim=True, unbiased=False)
    return (x - m) / torch.sqrt(v + eps)

def _scatter_add(tgt, idx, src, axis=0):
    return tgt.clone().index_add_(axis, idx, src)

def _segment_sum(src, seg, n):
    out = torch.zeros((n,) + src.shape[1:], dtype=src.dtype)
    return out.index_add_(0, seg, src)

def _pad(x, pw):
    flat = tuple((v for pair in reversed(pw) for v in pair))
    return torch.nn.functional.pad(x, flat)
kernel_name = 'concat_heads__memory_aug_recurrent_mem_tr__sliding_local_dilated__prompt'

def setup_inputs():

    _w = lambda a: (lambda t: t.to(torch.bfloat16) if t.is_floating_point() else t)(torch.as_tensor(a))

    def _A_setup():
        B, S, Dm = (1, 2048, 640)
        H, Dh = (32, 128)
        M, seg = (8, 32)
        seg = min(seg, S)
        S = S // seg * seg
        return {'x': _w((lambda *s: torch.randn(*s, dtype=torch.bfloat16) * 0.05)(B, S, Dm)), 'mem0': _w((lambda *s: torch.randn(*s, dtype=torch.bfloat16) * 1.6)(B, M, Dm)), 'Wq': _w((lambda *s: torch.randn(*s, dtype=torch.bfloat16) * 0.8)(Dm, H, Dh) * Dm ** (-0.5)), 'Wk': _w((lambda *s: torch.randn(*s, dtype=torch.bfloat16) * 0.8)(Dm, H, Dh) * Dm ** (-0.5)), 'Wv': _w((lambda *s: torch.randn(*s, dtype=torch.bfloat16) * 1.6)(Dm, H, Dh) * Dm ** (-0.5)), 'Wo': _w((lambda *s: torch.randn(*s, dtype=torch.bfloat16) * 1.6)(H, Dh, Dm) * (H * Dh) ** (-0.5)), 'seg_len': seg}
    _A_in = _A_setup()

    def _B_setup():
        B, S, D = (1, 2048, 640)
        return {'x': _w((lambda *s: torch.randn(*s, dtype=torch.bfloat16) * 0.2)(B, S, D)), 'wqkv': _w((lambda *s: torch.randn(*s, dtype=torch.bfloat16) * 0.2)(D, 3 * D)), 'wo': _w((lambda *s: torch.randn(*s, dtype=torch.bfloat16) * 0.05)(D, D))}
    _B_in = _B_setup()
    return {'A_x': _A_in['x'], 'A_mem0': _A_in['mem0'], 'A_Wq': _A_in['Wq'], 'A_Wk': _A_in['Wk'], 'A_Wv': _A_in['Wv'], 'A_Wo': _A_in['Wo'], 'A_seg_len': _A_in['seg_len'], 'B_x': _B_in['x'], 'B_wqkv': _B_in['wqkv'], 'B_wo': _B_in['wo']}

def reference(A_x, A_mem0, A_Wq, A_Wk, A_Wv, A_Wo, A_seg_len, B_x, B_wqkv, B_wo):

    def _A_ref(x, mem0, Wq, Wk, Wv, Wo, seg_len):
        B, S, Dm = x.shape
        H, Dh = (Wq.shape[1], Wq.shape[2])
        M = mem0.shape[1]
        scale = Dh ** (-0.5)
        n_seg = S // seg_len
        L = M + seg_len
        idx = torch.arange(L)
        mask = (idx[:, None] < M) | (idx[:, None] >= idx[None, :])
        mem = mem0
        outs = []
        for s in range(n_seg):
            xs = x[:, s * seg_len:(s + 1) * seg_len, :].clone()
            h = torch.concatenate([mem, xs], axis=1)
            q = torch.einsum('btd,dhe->bhte', h, Wq)
            k = torch.einsum('btd,dhe->bhte', h, Wk)
            v = torch.einsum('btd,dhe->bhte', h, Wv)
            scores = torch.einsum('bhqe,bhke->bhqk', q, k) * scale
            scores = torch.where(mask[None, None], scores, -1000000000.0)
            p = _softmax(scores, axis=-1)
            o = torch.einsum('bhqk,bhke->bhqe', p, v)
            o = torch.einsum('bhte,hed->btd', o, Wo)
            mem = o[:, :M, :].clone()
            outs.append(o[:, M:, :])
        return torch.concatenate(outs, axis=1)

    def _B_ref(x, wqkv, wo):
        B, S, D = x.shape
        H = 32
        Dh = D // H
        W, dil = (8, 2)
        qkv = (lambda x, *d: x.permute(*d))((x @ wqkv).reshape(B, S, 3, H, Dh), 2, 0, 3, 1, 4)
        q, k, v = (qkv[0], qkv[1], qkv[2])
        scale = Dh ** (-0.5)
        pos = torch.arange(S)
        off = torch.arange(W) * dil
        idx = pos[:, None] - off[None, :]
        mask = idx >= 0
        idx_c = torch.where(mask, idx, 0).reshape(-1)
        kg = k[:, :, idx_c, :].reshape(B, H, S, W, Dh)
        vg = v[:, :, idx_c, :].reshape(B, H, S, W, Dh)
        logits = torch.einsum('bhsd,bhswd->bhsw', q, kg) * scale
        logits = torch.where(mask[None, None, :, :], logits, -1000000000.0)
        attn = _softmax(logits, axis=-1)
        o = torch.einsum('bhsw,bhswd->bhsd', attn, vg)
        return (lambda x, *d: x.permute(*d))(o, 0, 2, 1, 3).reshape(B, S, D) @ wo
    a = _A_ref(A_x, A_mem0, A_Wq, A_Wk, A_Wv, A_Wo, A_seg_len)
    b = _B_ref(B_x, B_wqkv, B_wo)
    return torch.concatenate([a, b], axis=-1)
```

```asm
; @launch kernel=tr_kernel grid=(2916,1,1) block=(256,1,1) lds=9216
; @launch kernel=mega_kernel grid=(3165,1,1) block=(256,1,1) lds=163072
.amdgcn_target "amdgcn-amd-amdhsa--gfx950"
.text
.globl tr_kernel
.p2align 8
.type tr_kernel,@function
tr_kernel:
    s_load_dwordx2 s[96:97], s[0:1], 96
    s_waitcnt lgkmcnt(0)
    s_mov_b32 s98, 268435456
    s_mov_b32 s99, 0x00020000
    s_cmp_lt_u32 s2, 640
    s_cbranch_scc1 tr_m0
    s_cmp_lt_u32 s2, 1280
    s_cbranch_scc1 tr_m1
    s_cmp_lt_u32 s2, 1920
    s_cbranch_scc1 tr_m2
    s_cmp_lt_u32 s2, 2560
    s_cbranch_scc1 tr_m3
    s_sub_u32 s3, s2, 2560
    s_cmp_ge_u32 s3, 356
    s_cbranch_scc1 tr_end
    v_mov_b32 v4, 0
    v_mov_b32 v5, 0
    v_mov_b32 v6, 0
    v_mov_b32 v7, 0
    s_lshl_b32 s3, s3, 14
    s_add_u32 s3, s3, 146800640
    v_lshlrev_b32 v1, 6, v0
    v_add_u32 v1, s3, v1
    buffer_store_dwordx4 v[4:7], v1, s[96:99], 0 offen offset:0
    buffer_store_dwordx4 v[4:7], v1, s[96:99], 0 offen offset:16
    buffer_store_dwordx4 v[4:7], v1, s[96:99], 0 offen offset:32
    buffer_store_dwordx4 v[4:7], v1, s[96:99], 0 offen offset:48
    s_branch tr_end
tr_m0:
    s_load_dwordx2 s[8:9], s[0:1], 16
    s_waitcnt lgkmcnt(0)
    s_mov_b32 s10, 5242880
    s_mov_b32 s11, 0x00020000
    s_sub_u32 s3, s2, 0
    s_mov_b32 s5, 67108864
    s_mul_hi_u32 s4, s3, s5
    s_mul_i32 s5, s4, 64
    s_sub_u32 s5, s3, s5
    s_mul_i32 s6, s4, 524288
    s_lshl_b32 s7, s5, 7
    s_add_u32 s6, s6, s7
    s_mul_i32 s12, s5, 81920
    s_lshl_b32 s7, s4, 7
    s_add_u32 s12, s12, s7
    s_add_u32 s12, s12, 0
    s_mov_b32 s13, 8192
    s_mov_b32 s14, 1280
    s_mov_b32 s17, 0
    s_mov_b32 s16, 0
    s_branch tr_go
tr_m1:
    s_load_dwordx2 s[8:9], s[0:1], 24
    s_waitcnt lgkmcnt(0)
    s_mov_b32 s10, 5242880
    s_mov_b32 s11, 0x00020000
    s_sub_u32 s3, s2, 640
    s_mov_b32 s5, 67108864
    s_mul_hi_u32 s4, s3, s5
    s_mul_i32 s5, s4, 64
    s_sub_u32 s5, s3, s5
    s_mul_i32 s6, s4, 524288
    s_lshl_b32 s7, s5, 7
    s_add_u32 s6, s6, s7
    s_mul_i32 s12, s5, 81920
    s_lshl_b32 s7, s4, 7
    s_add_u32 s12, s12, s7
    s_add_u32 s12, s12, 5242880
    s_mov_b32 s13, 8192
    s_mov_b32 s14, 1280
    s_mov_b32 s17, 0
    s_mov_b32 s16, 0
    s_branch tr_go
tr_m2:
    s_load_dwordx2 s[8:9], s[0:1], 32
    s_waitcnt lgkmcnt(0)
    s_mov_b32 s10, 5242880
    s_mov_b32 s11, 0x00020000
    s_sub_u32 s3, s2, 1280
    s_mov_b32 s5, 67108864
    s_mul_hi_u32 s4, s3, s5
    s_mul_i32 s5, s4, 64
    s_sub_u32 s5, s3, s5
    s_mul_i32 s6, s4, 524288
    s_lshl_b32 s7, s5, 7
    s_add_u32 s6, s6, s7
    s_mul_i32 s12, s5, 81920
    s_lshl_b32 s7, s4, 7
    s_add_u32 s12, s12, s7
    s_add_u32 s12, s12, 10485760
    s_mov_b32 s13, 8192
    s_mov_b32 s14, 1280
    s_mov_b32 s17, 0
    s_mov_b32 s16, 0
    s_branch tr_go
tr_m3:
    s_load_dwordx2 s[8:9], s[0:1], 40
    s_waitcnt lgkmcnt(0)
    s_mov_b32 s10, 5242880
    s_mov_b32 s11, 0x00020000
    s_sub_u32 s3, s2, 1920
    s_mov_b32 s5, 429496730
    s_mul_hi_u32 s4, s3, s5
    s_mul_i32 s5, s4, 10
    s_sub_u32 s5, s3, s5
    s_mul_i32 s6, s4, 81920
    s_lshl_b32 s7, s5, 7
    s_add_u32 s6, s6, s7
    s_mul_i32 s12, s5, 524288
    s_lshl_b32 s7, s4, 7
    s_add_u32 s12, s12, s7
    s_add_u32 s12, s12, 16777216
    s_mov_b32 s13, 1280
    s_mov_b32 s14, 8192
    s_mov_b32 s17, 0
    s_mov_b32 s16, 0
    s_branch tr_go
tr_go:
    v_lshrrev_b32 v1, 4, v0
    v_and_b32 v2, 15, v0
    v_mul_lo_u32 v3, v1, s13
    v_lshl_add_u32 v3, v2, 3, v3
    v_add_u32 v3, s6, v3
    v_mul_u32_u24 v4, 136, v1
    v_lshl_add_u32 v4, v2, 3, v4
    s_lshl_b32 s15, s13, 4
    buffer_load_dwordx2 v[8:9], v3, s[8:11], 0 offen
    v_add_u32 v3, s15, v3
    buffer_load_dwordx2 v[10:11], v3, s[8:11], 0 offen
    v_add_u32 v3, s15, v3
    buffer_load_dwordx2 v[12:13], v3, s[8:11], 0 offen
    v_add_u32 v3, s15, v3
    buffer_load_dwordx2 v[14:15], v3, s[8:11], 0 offen
    v_add_u32 v3, s15, v3
    s_waitcnt vmcnt(0)
    ds_write_b64 v4, v[8:9] offset:0
    ds_write_b64 v4, v[10:11] offset:2176
    ds_write_b64 v4, v[12:13] offset:4352
    ds_write_b64 v4, v[14:15] offset:6528
    s_waitcnt lgkmcnt(0)
    s_barrier
    v_mul_u32_u24 v4, 544, v2
    v_lshl_add_u32 v4, v1, 1, v4
    v_mul_lo_u32 v3, v1, s14
    v_lshl_add_u32 v3, v2, 3, v3
    v_add_u32 v3, s12, v3
    s_lshl_b32 s15, s14, 4
    ds_read_u16 v8, v4 offset:0
    ds_read_u16 v10, v4 offset:136
    ds_read_u16 v9, v4 offset:272
    ds_read_u16 v11, v4 offset:408
    ds_read_u16 v12, v4 offset:32
    ds_read_u16 v14, v4 offset:168
    ds_read_u16 v13, v4 offset:304
    ds_read_u16 v15, v4 offset:440
    ds_read_u16 v16, v4 offset:64
    ds_read_u16 v18, v4 offset:200
    ds_read_u16 v17, v4 offset:336
    ds_read_u16 v19, v4 offset:472
    ds_read_u16 v20, v4 offset:96
    ds_read_u16 v22, v4 offset:232
    ds_read_u16 v21, v4 offset:368
    ds_read_u16 v23, v4 offset:504
    v_add_u32 v24, s15, v3
    v_add_u32 v25, s15, v24
    v_add_u32 v26, s15, v25
    v_lshrrev_b32 v27, 1, v2
    v_lshlrev_b32 v27, 8, v27
    v_lshl_add_u32 v27, v1, 4, v27
    v_and_b32 v28, 1, v2
    v_lshl_add_u32 v27, v28, 3, v27
    v_add_u32 v27, s16, v27
    v_add_u32 v28, s15, v27
    v_add_u32 v29, s15, v28
    v_add_u32 v30, s15, v29
    s_waitcnt lgkmcnt(12)
    v_lshl_or_b32 v8, v10, 16, v8
    v_lshl_or_b32 v9, v11, 16, v9
    buffer_store_dwordx2 v[8:9], v3, s[96:99], 0 offen
    s_waitcnt lgkmcnt(8)
    v_lshl_or_b32 v12, v14, 16, v12
    v_lshl_or_b32 v13, v15, 16, v13
    buffer_store_dwordx2 v[12:13], v24, s[96:99], 0 offen
    s_waitcnt lgkmcnt(4)
    v_lshl_or_b32 v16, v18, 16, v16
    v_lshl_or_b32 v17, v19, 16, v17
    buffer_store_dwordx2 v[16:17], v25, s[96:99], 0 offen
    s_waitcnt lgkmcnt(0)
    v_lshl_or_b32 v20, v22, 16, v20
    v_lshl_or_b32 v21, v23, 16, v21
    buffer_store_dwordx2 v[20:21], v26, s[96:99], 0 offen
    s_cmp_eq_u32 s17, 0
    s_cbranch_scc1 tr_end
    buffer_store_dwordx2 v[8:9], v27, s[96:99], 0 offen
    buffer_store_dwordx2 v[12:13], v28, s[96:99], 0 offen
    buffer_store_dwordx2 v[16:17], v29, s[96:99], 0 offen
    buffer_store_dwordx2 v[20:21], v30, s[96:99], 0 offen
tr_end:
    s_endpgm
.globl mega_kernel
.p2align 8
.type mega_kernel,@function
mega_kernel:
    s_cmp_ge_u32 s2, 128
    s_cbranch_scc1 wk_entry
    s_load_dwordx2 s[96:97], s[0:1], 96
    s_waitcnt lgkmcnt(0)
    s_mov_b32 s98, 268435456
    s_mov_b32 s99, 0x00020000
    s_load_dwordx2 s[8:9], s[0:1], 8
    s_waitcnt lgkmcnt(0)
    s_mov_b32 s10, 10240
    s_mov_b32 s11, 0x00020000
    s_and_b32 s31, s2, 31
    s_lshr_b32 s6, s2, 5
    v_lshrrev_b32 v1, 6, v0
    v_and_b32 v2, 63, v0
    s_nop 0
    v_readfirstlane_b32 s7, v1
    v_and_b32 v76, 15, v2
    v_lshrrev_b32 v77, 4, v2
    v_lshrrev_b32 v82, 5, v0
    v_and_b32 v83, 31, v0
    v_mul_u32_u24 v84, 1280, v82
    v_lshl_add_u32 v84, v83, 3, v84
    v_mul_u32_u24 v86, 1312, v82
    v_lshrrev_b32 v85, 2, v83
    v_lshl_add_u32 v86, v85, 5, v86
    v_and_b32 v85, 3, v83
    v_lshl_add_u32 v86, v85, 2, v86
    v_add_u32 v86, 143360, v86
    buffer_load_dwordx2 v[100:101], v84, s[8:11], 0 offen offset:0
    buffer_load_dwordx2 v[102:103], v84, s[8:11], 0 offen offset:256
    buffer_load_dwordx2 v[104:105], v84, s[8:11], 0 offen offset:512
    buffer_load_dwordx2 v[106:107], v84, s[8:11], 0 offen offset:768
    buffer_load_dwordx2 v[108:109], v84, s[8:11], 0 offen offset:1024
    s_lshl_b32 s16, s31, 7
    s_lshl_b32 s17, s7, 5
    s_add_u32 s17, s17, s16
    s_add_u32 s19, s17, 0
    v_add_u32 v88, s19, v76
    v_mul_u32_u24 v88, 1280, v88
    v_lshl_add_u32 v88, v77, 4, v88
    s_add_u32 s19, s17, 16
    v_add_u32 v89, s19, v76
    v_mul_u32_u24 v89, 1280, v89
    v_lshl_add_u32 v89, v77, 4, v89
    s_add_u32 s19, s17, 4096
    v_add_u32 v90, s19, v76
    v_mul_u32_u24 v90, 1280, v90
    v_lshl_add_u32 v90, v77, 4, v90
    s_add_u32 s19, s17, 4112
    v_add_u32 v91, s19, v76
    v_mul_u32_u24 v91, 1280, v91
    v_lshl_add_u32 v91, v77, 4, v91
    s_add_u32 s19, s17, 8192
    v_add_u32 v92, s19, v76
    v_mul_u32_u24 v92, 1280, v92
    v_lshl_add_u32 v92, v77, 4, v92
    s_add_u32 s19, s17, 8208
    v_add_u32 v93, s19, v76
    v_mul_u32_u24 v93, 1280, v93
    v_lshl_add_u32 v93, v77, 4, v93
    buffer_load_dwordx4 v[124:127], v92, s[96:99], 0 offen offset:0
    buffer_load_dwordx4 v[128:131], v92, s[96:99], 0 offen offset:64
    buffer_load_dwordx4 v[132:135], v92, s[96:99], 0 offen offset:128
    buffer_load_dwordx4 v[136:139], v92, s[96:99], 0 offen offset:192
    buffer_load_dwordx4 v[140:143], v92, s[96:99], 0 offen offset:256
    buffer_load_dwordx4 v[144:147], v92, s[96:99], 0 offen offset:320
    buffer_load_dwordx4 v[148:151], v92, s[96:99], 0 offen offset:384
    buffer_load_dwordx4 v[152:155], v92, s[96:99], 0 offen offset:448
    buffer_load_dwordx4 v[156:159], v92, s[96:99], 0 offen offset:512
    buffer_load_dwordx4 v[160:163], v92, s[96:99], 0 offen offset:576
    buffer_load_dwordx4 v[164:167], v92, s[96:99], 0 offen offset:640
    buffer_load_dwordx4 v[168:171], v92, s[96:99], 0 offen offset:704
    buffer_load_dwordx4 v[172:175], v92, s[96:99], 0 offen offset:768
    buffer_load_dwordx4 v[176:179], v92, s[96:99], 0 offen offset:832
    buffer_load_dwordx4 v[180:183], v92, s[96:99], 0 offen offset:896
    buffer_load_dwordx4 v[184:187], v92, s[96:99], 0 offen offset:960
    buffer_load_dwordx4 v[188:191], v92, s[96:99], 0 offen offset:1024
    buffer_load_dwordx4 v[192:195], v93, s[96:99], 0 offen offset:0
    buffer_load_dwordx4 v[196:199], v93, s[96:99], 0 offen offset:64
    buffer_load_dwordx4 v[200:203], v93, s[96:99], 0 offen offset:128
    buffer_load_dwordx4 v[204:207], v93, s[96:99], 0 offen offset:192
    buffer_load_dwordx4 v[208:211], v93, s[96:99], 0 offen offset:256
    buffer_load_dwordx4 v[212:215], v93, s[96:99], 0 offen offset:320
    buffer_load_dwordx4 v[216:219], v93, s[96:99], 0 offen offset:384
    buffer_load_dwordx4 v[220:223], v93, s[96:99], 0 offen offset:448
    buffer_load_dwordx4 v[224:227], v93, s[96:99], 0 offen offset:512
    buffer_load_dwordx4 v[228:231], v93, s[96:99], 0 offen offset:576
    buffer_load_dwordx4 v[232:235], v93, s[96:99], 0 offen offset:640
    buffer_load_dwordx4 v[236:239], v93, s[96:99], 0 offen offset:704
    buffer_load_dwordx4 v[240:243], v93, s[96:99], 0 offen offset:768
    buffer_load_dwordx4 v[244:247], v93, s[96:99], 0 offen offset:832
    buffer_load_dwordx4 v[248:251], v93, s[96:99], 0 offen offset:896
    buffer_load_dwordx4 v[252:255], v93, s[96:99], 0 offen offset:960
    buffer_load_dwordx4 v[36:39], v93, s[96:99], 0 offen offset:1024
    buffer_load_dwordx4 v[40:43], v93, s[96:99], 0 offen offset:1088
    buffer_load_dwordx4 a[0:3], v88, s[96:99], 0 offen offset:0
    buffer_load_dwordx4 a[4:7], v88, s[96:99], 0 offen offset:64
    buffer_load_dwordx4 a[8:11], v88, s[96:99], 0 offen offset:128
    buffer_load_dwordx4 a[12:15], v88, s[96:99], 0 offen offset:192
    buffer_load_dwordx4 a[16:19], v88, s[96:99], 0 offen offset:256
    buffer_load_dwordx4 a[20:23], v88, s[96:99], 0 offen offset:320
    buffer_load_dwordx4 a[24:27], v88, s[96:99], 0 offen offset:384
    buffer_load_dwordx4 a[28:31], v88, s[96:99], 0 offen offset:448
    buffer_load_dwordx4 a[32:35], v88, s[96:99], 0 offen offset:512
    buffer_load_dwordx4 a[36:39], v88, s[96:99], 0 offen offset:576
    buffer_load_dwordx4 a[40:43], v88, s[96:99], 0 offen offset:640
    buffer_load_dwordx4 a[44:47], v88, s[96:99], 0 offen offset:704
    buffer_load_dwordx4 a[48:51], v88, s[96:99], 0 offen offset:768
    buffer_load_dwordx4 a[52:55], v88, s[96:99], 0 offen offset:832
    buffer_load_dwordx4 a[56:59], v88, s[96:99], 0 offen offset:896
    buffer_load_dwordx4 a[60:63], v88, s[96:99], 0 offen offset:960
    buffer_load_dwordx4 a[64:67], v88, s[96:99], 0 offen offset:1024
    buffer_load_dwordx4 a[68:71], v88, s[96:99], 0 offen offset:1088
    buffer_load_dwordx4 a[72:75], v88, s[96:99], 0 offen offset:1152
    buffer_load_dwordx4 a[76:79], v88, s[96:99], 0 offen offset:1216
    v_lshrrev_b32 v78, 2, v76
    v_and_b32 v1, 1, v76
    v_lshl_add_u32 v78, v78, 1, v1
    v_and_b32 v79, 3, v2
    v_bfe_u32 v80, v2, 2, 3
    v_lshrrev_b32 v81, 5, v2
    v_mul_u32_u24 v5, 1312, v78
    v_lshl_add_u32 v5, v77, 5, v5
    v_bfe_u32 v1, v76, 1, 1
    v_lshl_add_u32 v5, v1, 4, v5
    v_add_u32 v5, 143360, v5
    s_mul_i32 s16, s7, 22528
    v_lshrrev_b32 v6, 2, v2
    v_mul_u32_u24 v6, 256, v6
    v_lshl_add_u32 v6, v79, 4, v6
    v_add_u32 v6, s16, v6
    v_mul_u32_u24 v8, 256, v80
    v_lshl_add_u32 v8, v79, 4, v8
    v_add_u32 v8, s16, v8
    s_mul_i32 s18, s7, 320
    s_add_u32 s18, s18, 143360
    v_mul_u32_u24 v82, 1312, v80
    v_add_u32 v82, s18, v82
    v_mul_u32_u24 v83, 24, v81
    v_lshl_add_u32 v10, v79, 3, v82
    v_add_u32 v9, v10, v83
    v_add_u32 v10, 240, v10
    v_add_u32 v11, v82, v83
    v_add_u32 v11, 264, v11
    v_lshl_add_u32 v12, v81, 2, v82
    v_add_u32 v12, 312, v12
    s_lshl_b32 s18, s7, 10
    s_add_u32 s18, s18, 153856
    v_lshlrev_b32 v13, 7, v77
    v_lshl_add_u32 v13, v78, 4, v13
    v_add_u32 v13, s18, v13
    s_lshl_b32 s18, s7, 8
    s_add_u32 s18, s18, 157952
    v_lshlrev_b32 v14, 6, v77
    v_lshl_add_u32 v14, v78, 3, v14
    v_add_u32 v14, s18, v14
    v_lshrrev_b32 v82, 3, v76
    v_and_b32 v83, 7, v76
    v_lshlrev_b32 v15, 9, v82
    v_lshl_add_u32 v15, v77, 7, v15
    v_lshl_add_u32 v15, v83, 4, v15
    v_add_u32 v15, 153856, v15
    v_lshlrev_b32 v16, 6, v77
    v_lshl_add_u32 v16, v83, 3, v16
    v_lshl_add_u32 v16, v82, 2, v16
    v_add_u32 v16, 157952, v16
    v_lshlrev_b32 v18, 4, v2
    v_add_u32 v18, 158976, v18
    s_lshl_b32 s18, s7, 10
    v_add_u32 v17, s18, v18
    s_add_u32 s18, s18, 158976
    v_lshrrev_b32 v82, 2, v76
    v_and_b32 v83, 3, v76
    v_lshlrev_b32 v25, 7, v82
    v_lshl_add_u32 v25, v77, 5, v25
    v_lshl_add_u32 v25, v83, 1, v25
    v_add_u32 v25, s18, v25
    s_lshl_b32 s18, s7, 6
    v_lshlrev_b32 v19, 14, v76
    v_lshl_add_u32 v19, v77, 3, v19
    v_add_u32 v19, s18, v19
    v_add_u32 v20, 0x40000, v19
    v_lshlrev_b32 v22, 8, v78
    v_lshl_add_u32 v22, v77, 3, v22
    v_add_u32 v22, s18, v22
    v_add_u32 v22, 157286400, v22
    s_lshl_b32 s18, s7, 5
    v_add_u32 v82, s18, v76
    v_lshlrev_b32 v21, 6, v82
    v_lshl_add_u32 v21, v77, 3, v21
    v_lshlrev_b32 v23, 4, v82
    v_lshl_add_u32 v23, v77, 2, v23
    v_add_u32 v23, 161480704, v23
    s_mul_i32 s18, s7, 35840
    v_lshlrev_b32 v24, 4, v2
    v_add_u32 v24, s18, v24
    v_cmp_eq_u32 s[52:53], 3, v79
    v_cmp_ne_u32 s[54:55], 3, v79
    v_cmp_eq_u32 s[56:57], 15, v76
    v_mov_b32 v26, 0
    v_mov_b32 v27, 0
    v_mov_b32 v28, 0
    v_mov_b32 v29, 0
    v_mov_b32 v30, 0
    v_mov_b32 v31, 0
    v_mov_b32 v4, 0
    v_mov_b32 v7, 0
    s_lshl_b32 s44, s31, 8
    s_add_u32 s44, s44, 33562624
    s_lshl_b32 s45, s31, 13
    s_add_u32 s45, s45, 67108864
    s_lshl_b32 s46, s31, 11
    s_lshr_b32 s47, s31, 2
    s_lshl_b32 s47, s47, 8
    s_and_b32 s16, s31, 3
    s_lshl_b32 s16, s16, 3
    s_add_u32 s47, s47, s16
    s_lshl_b32 s16, s6, 2
    s_add_u32 s47, s47, s16
    s_add_u32 s47, s47, 152600576
    s_mul_i32 s16, s6, 160
    s_lshl_b32 s58, s31, 8
    s_add_u32 s58, s58, 16777216
    v_cmp_eq_u32 s[60:61], 12, v76
    v_cmp_eq_u32 s[62:63], 13, v76
    v_cmp_eq_u32 s[64:65], 14, v76
    v_cmp_eq_u32 s[66:67], 15, v76
    s_mul_i32 s20, s31, 47
    s_lshr_b32 s20, s20, 9
    s_mul_i32 s20, s20, 11
    s_sub_u32 s20, s31, s20
    s_mul_i32 s21, s7, 3
    s_add_u32 s20, s20, s21
    s_add_u32 s21, s20, 0
    s_sub_u32 s22, s21, 11
    s_cmp_ge_u32 s21, 11
    s_cselect_b32 s21, s22, s21
    s_mul_i32 s70, s21, 2048
    s_mul_i32 s22, s21, 12
    v_add_u32 v94, s22, v76
    s_lshr_b32 s22, s21, 1
    s_mul_i32 s22, s22, 3
    s_and_b32 s23, s21, 1
    s_add_u32 s24, s22, 0
    s_mul_i32 s25, s23, 12
    s_add_u32 s25, s25, 132
    s_add_u32 s25, s25, s24
    s_lshl_b32 s26, s23, 1
    s_add_u32 s26, s26, 144
    s_add_u32 s26, s26, s24
    s_cmp_lt_u32 s24, 12
    s_cselect_b32 s25, s25, s26
    s_cmp_lt_u32 s24, 14
    s_cselect_b32 s25, s25, 0x20000
    v_mov_b32 v82, s25
    v_cndmask_b32 v94, v94, v82, s[60:61]
    s_add_u32 s24, s22, 1
    s_mul_i32 s25, s23, 12
    s_add_u32 s25, s25, 132
    s_add_u32 s25, s25, s24
    s_lshl_b32 s26, s23, 1
    s_add_u32 s26, s26, 144
    s_add_u32 s26, s26, s24
    s_cmp_lt_u32 s24, 12
    s_cselect_b32 s25, s25, s26
    s_cmp_lt_u32 s24, 14
    s_cselect_b32 s25, s25, 0x20000
    v_mov_b32 v82, s25
    v_cndmask_b32 v94, v94, v82, s[62:63]
    s_add_u32 s24, s22, 2
    s_mul_i32 s25, s23, 12
    s_add_u32 s25, s25, 132
    s_add_u32 s25, s25, s24
    s_lshl_b32 s26, s23, 1
    s_add_u32 s26, s26, 144
    s_add_u32 s26, s26, s24
    s_cmp_lt_u32 s24, 12
    s_cselect_b32 s25, s25, s26
    s_cmp_lt_u32 s24, 14
    s_cselect_b32 s25, s25, 0x20000
    v_mov_b32 v82, s25
    v_cndmask_b32 v94, v94, v82, s[64:65]
    s_mov_b32 s25, 0x20000
    v_mov_b32 v82, s25
    v_cndmask_b32 v94, v94, v82, s[66:67]
    v_bfe_u32 v82, v94, 1, 2
    v_bfe_u32 v83, v94, 3, 1
    v_and_b32 v94, 0xfffffff1, v94
    v_lshl_or_b32 v94, v82, 2, v94
    v_lshl_or_b32 v94, v83, 1, v94
    v_add_u32 v94, s16, v94
    v_lshlrev_b32 v94, 13, v94
    v_lshl_add_u32 v94, v77, 3, v94
    s_add_u32 s21, s20, 1
    s_sub_u32 s22, s21, 11
    s_cmp_ge_u32 s21, 11
    s_cselect_b32 s21, s22, s21
    s_mul_i32 s71, s21, 2048
    s_mul_i32 s22, s21, 12
    v_add_u32 v95, s22, v76
    s_lshr_b32 s22, s21, 1
    s_mul_i32 s22, s22, 3
    s_and_b32 s23, s21, 1
    s_add_u32 s24, s22, 0
    s_mul_i32 s25, s23, 12
    s_add_u32 s25, s25, 132
    s_add_u32 s25, s25, s24
    s_lshl_b32 s26, s23, 1
    s_add_u32 s26, s26, 144
    s_add_u32 s26, s26, s24
    s_cmp_lt_u32 s24, 12
    s_cselect_b32 s25, s25, s26
    s_cmp_lt_u32 s24, 14
    s_cselect_b32 s25, s25, 0x20000
    v_mov_b32 v82, s25
    v_cndmask_b32 v95, v95, v82, s[60:61]
    s_add_u32 s24, s22, 1
    s_mul_i32 s25, s23, 12
    s_add_u32 s25, s25, 132
    s_add_u32 s25, s25, s24
    s_lshl_b32 s26, s23, 1
    s_add_u32 s26, s26, 144
    s_add_u32 s26, s26, s24
    s_cmp_lt_u32 s24, 12
    s_cselect_b32 s25, s25, s26
    s_cmp_lt_u32 s24, 14
    s_cselect_b32 s25, s25, 0x20000
    v_mov_b32 v82, s25
    v_cndmask_b32 v95, v95, v82, s[62:63]
    s_add_u32 s24, s22, 2
    s_mul_i32 s25, s23, 12
    s_add_u32 s25, s25, 132
    s_add_u32 s25, s25, s24
    s_lshl_b32 s26, s23, 1
    s_add_u32 s26, s26, 144
    s_add_u32 s26, s26, s24
    s_cmp_lt_u32 s24, 12
    s_cselect_b32 s25, s25, s26
    s_cmp_lt_u32 s24, 14
    s_cselect_b32 s25, s25, 0x20000
    v_mov_b32 v82, s25
    v_cndmask_b32 v95, v95, v82, s[64:65]
    s_mov_b32 s25, 0x20000
    v_mov_b32 v82, s25
    v_cndmask_b32 v95, v95, v82, s[66:67]
    v_bfe_u32 v82, v95, 1, 2
    v_bfe_u32 v83, v95, 3, 1
    v_and_b32 v95, 0xfffffff1, v95
    v_lshl_or_b32 v95, v82, 2, v95
    v_lshl_or_b32 v95, v83, 1, v95
    v_add_u32 v95, s16, v95
    v_lshlrev_b32 v95, 13, v95
    v_lshl_add_u32 v95, v77, 3, v95
    s_add_u32 s21, s20, 2
    s_sub_u32 s22, s21, 11
    s_cmp_ge_u32 s21, 11
    s_cselect_b32 s21, s22, s21
    s_mul_i32 s72, s21, 2048
    s_mul_i32 s22, s21, 12
    v_add_u32 v96, s22, v76
    s_lshr_b32 s22, s21, 1
    s_mul_i32 s22, s22, 3
    s_and_b32 s23, s21, 1
    s_add_u32 s24, s22, 0
    s_mul_i32 s25, s23, 12
    s_add_u32 s25, s25, 132
    s_add_u32 s25, s25, s24
    s_lshl_b32 s26, s23, 1
    s_add_u32 s26, s26, 144
    s_add_u32 s26, s26, s24
    s_cmp_lt_u32 s24, 12
    s_cselect_b32 s25, s25, s26
    s_cmp_lt_u32 s24, 14
    s_cselect_b32 s25, s25, 0x20000
    v_mov_b32 v82, s25
    v_cndmask_b32 v96, v96, v82, s[60:61]
    s_add_u32 s24, s22, 1
    s_mul_i32 s25, s23, 12
    s_add_u32 s25, s25, 132
    s_add_u32 s25, s25, s24
    s_lshl_b32 s26, s23, 1
    s_add_u32 s26, s26, 144
    s_add_u32 s26, s26, s24
    s_cmp_lt_u32 s24, 12
    s_cselect_b32 s25, s25, s26
    s_cmp_lt_u32 s24, 14
    s_cselect_b32 s25, s25, 0x20000
    v_mov_b32 v82, s25
    v_cndmask_b32 v96, v96, v82, s[62:63]
    s_add_u32 s24, s22, 2
    s_mul_i32 s25, s23, 12
    s_add_u32 s25, s25, 132
    s_add_u32 s25, s25, s24
    s_lshl_b32 s26, s23, 1
    s_add_u32 s26, s26, 144
    s_add_u32 s26, s26, s24
    s_cmp_lt_u32 s24, 12
    s_cselect_b32 s25, s25, s26
    s_cmp_lt_u32 s24, 14
    s_cselect_b32 s25, s25, 0x20000
    v_mov_b32 v82, s25
    v_cndmask_b32 v96, v96, v82, s[64:65]
    s_mov_b32 s25, 0x20000
    v_mov_b32 v82, s25
    v_cndmask_b32 v96, v96, v82, s[66:67]
    v_bfe_u32 v82, v96, 1, 2
    v_bfe_u32 v83, v96, 3, 1
    v_and_b32 v96, 0xfffffff1, v96
    v_lshl_or_b32 v96, v82, 2, v96
    v_lshl_or_b32 v96, v83, 1, v96
    v_add_u32 v96, s16, v96
    v_lshlrev_b32 v96, 13, v96
    v_lshl_add_u32 v96, v77, 3, v96
    s_cmp_eq_u32 s7, 3
    s_cselect_b32 s72, 0x40000000, s72
    v_and_b32 v82, 1, v77
    v_mul_u32_u24 v82, 1024, v82
    v_lshl_add_u32 v82, v76, 2, v82
    s_mul_i32 s16, s6, 22528
    v_add_u32 v82, s16, v82
    s_add_u32 s73, s72, 512
    v_cmp_gt_u32 vcc, 2, v77
    v_mov_b32 v83, s70
    v_mov_b32 v84, s71
    v_cndmask_b32 v83, v84, v83, vcc
    v_add_u32 v0, v82, v83
    v_mov_b32 v83, s72
    v_mov_b32 v84, s73
    v_cndmask_b32 v83, v84, v83, vcc
    v_add_u32 v3, v82, v83
    v_bfe_u32 v82, v76, 1, 1
    v_mul_u32_u24 v82, 0xaaaa, v82
    v_add_u32 v2, 0x4444, v82
    s_waitcnt vmcnt(20)
    ds_write_b32 v86, v100 offset:0
    ds_write_b32 v86, v101 offset:16
    ds_write_b32 v86, v102 offset:256
    ds_write_b32 v86, v103 offset:272
    ds_write_b32 v86, v104 offset:512
    ds_write_b32 v86, v105 offset:528
    ds_write_b32 v86, v106 offset:768
    ds_write_b32 v86, v107 offset:784
    ds_write_b32 v86, v108 offset:1024
    ds_write_b32 v86, v109 offset:1040
    ds_write_b128 v24, v[124:127] offset:0
    ds_write_b128 v24, v[128:131] offset:1024
    ds_write_b128 v24, v[132:135] offset:2048
    ds_write_b128 v24, v[136:139] offset:3072
    ds_write_b128 v24, v[140:143] offset:4096
    ds_write_b128 v24, v[144:147] offset:5120
    ds_write_b128 v24, v[148:151] offset:6144
    ds_write_b128 v24, v[152:155] offset:7168
    ds_write_b128 v24, v[156:159] offset:8192
    ds_write_b128 v24, v[160:163] offset:9216
    ds_write_b128 v24, v[164:167] offset:10240
    ds_write_b128 v24, v[168:171] offset:11264
    ds_write_b128 v24, v[172:175] offset:12288
    ds_write_b128 v24, v[176:179] offset:13312
    ds_write_b128 v24, v[180:183] offset:14336
    ds_write_b128 v24, v[184:187] offset:15360
    ds_write_b128 v24, v[188:191] offset:16384
    ds_write_b128 v24, v[192:195] offset:17408
    ds_write_b128 v24, v[196:199] offset:18432
    ds_write_b128 v24, v[200:203] offset:19456
    ds_write_b128 v24, v[204:207] offset:20480
    ds_write_b128 v24, v[208:211] offset:21504
    ds_write_b128 v24, v[212:215] offset:22528
    ds_write_b128 v24, v[216:219] offset:23552
    ds_write_b128 v24, v[220:223] offset:24576
    ds_write_b128 v24, v[224:227] offset:25600
    ds_write_b128 v24, v[228:231] offset:26624
    ds_write_b128 v24, v[232:235] offset:27648
    ds_write_b128 v24, v[236:239] offset:28672
    ds_write_b128 v24, v[240:243] offset:29696
    ds_write_b128 v24, v[244:247] offset:30720
    ds_write_b128 v24, v[248:251] offset:31744
    ds_write_b128 v24, v[252:255] offset:32768
    ds_write_b128 v24, v[36:39] offset:33792
    ds_write_b128 v24, v[40:43] offset:34816
    buffer_load_dwordx4 a[80:83], v89, s[96:99], 0 offen offset:0
    buffer_load_dwordx4 a[84:87], v89, s[96:99], 0 offen offset:64
    buffer_load_dwordx4 a[88:91], v89, s[96:99], 0 offen offset:128
    buffer_load_dwordx4 a[92:95], v89, s[96:99], 0 offen offset:192
    buffer_load_dwordx4 a[96:99], v89, s[96:99], 0 offen offset:256
    buffer_load_dwordx4 a[100:103], v89, s[96:99], 0 offen offset:320
    buffer_load_dwordx4 a[104:107], v89, s[96:99], 0 offen offset:384
    buffer_load_dwordx4 a[108:111], v89, s[96:99], 0 offen offset:448
    buffer_load_dwordx4 a[112:115], v89, s[96:99], 0 offen offset:512
    buffer_load_dwordx4 a[116:119], v89, s[96:99], 0 offen offset:576
    buffer_load_dwordx4 a[120:123], v89, s[96:99], 0 offen offset:640
    buffer_load_dwordx4 a[124:127], v89, s[96:99], 0 offen offset:704
    buffer_load_dwordx4 a[128:131], v89, s[96:99], 0 offen offset:768
    buffer_load_dwordx4 a[132:135], v89, s[96:99], 0 offen offset:832
    buffer_load_dwordx4 a[136:139], v89, s[96:99], 0 offen offset:896
    buffer_load_dwordx4 a[140:143], v89, s[96:99], 0 offen offset:960
    buffer_load_dwordx4 a[144:147], v89, s[96:99], 0 offen offset:1024
    buffer_load_dwordx4 a[148:151], v89, s[96:99], 0 offen offset:1088
    buffer_load_dwordx4 a[152:155], v89, s[96:99], 0 offen offset:1152
    buffer_load_dwordx4 a[156:159], v89, s[96:99], 0 offen offset:1216
    s_waitcnt lgkmcnt(0)
    v_mov_b32 v36, 0
    v_mov_b32 v37, 0
    v_mov_b32 v38, 0
    v_mov_b32 v39, 0
    v_mov_b32 v40, 0
    v_mov_b32 v41, 0
    v_mov_b32 v42, 0
    v_mov_b32 v43, 0
    v_mov_b32 v44, 0
    v_mov_b32 v45, 0
    v_mov_b32 v46, 0
    v_mov_b32 v47, 0
    v_mov_b32 v48, 0
    v_mov_b32 v49, 0
    v_mov_b32 v50, 0
    v_mov_b32 v51, 0
    v_mov_b32 v52, 0
    v_mov_b32 v53, 0
    v_mov_b32 v54, 0
    v_mov_b32 v55, 0
    v_mov_b32 v56, 0
    v_mov_b32 v57, 0
    v_mov_b32 v58, 0
    v_mov_b32 v59, 0
    buffer_load_dwordx4 a[160:163], v90, s[96:99], 0 offen offset:0
    buffer_load_dwordx4 a[164:167], v90, s[96:99], 0 offen offset:64
    buffer_load_dwordx4 a[168:171], v90, s[96:99], 0 offen offset:128
    buffer_load_dwordx4 a[172:175], v90, s[96:99], 0 offen offset:192
    buffer_load_dwordx4 a[176:179], v90, s[96:99], 0 offen offset:256
    buffer_load_dwordx4 a[180:183], v90, s[96:99], 0 offen offset:320
    buffer_load_dwordx4 a[184:187], v90, s[96:99], 0 offen offset:384
    buffer_load_dwordx4 a[188:191], v90, s[96:99], 0 offen offset:448
    buffer_load_dwordx4 a[192:195], v90, s[96:99], 0 offen offset:512
    buffer_load_dwordx4 a[196:199], v90, s[96:99], 0 offen offset:576
    buffer_load_dwordx4 a[200:203], v90, s[96:99], 0 offen offset:640
    buffer_load_dwordx4 a[204:207], v90, s[96:99], 0 offen offset:704
    buffer_load_dwordx4 a[208:211], v90, s[96:99], 0 offen offset:768
    buffer_load_dwordx4 a[212:215], v90, s[96:99], 0 offen offset:832
    buffer_load_dwordx4 a[216:219], v90, s[96:99], 0 offen offset:896
    buffer_load_dwordx4 a[220:223], v90, s[96:99], 0 offen offset:960
    buffer_load_dwordx4 a[224:227], v90, s[96:99], 0 offen offset:1024
    buffer_load_dwordx4 a[228:231], v90, s[96:99], 0 offen offset:1088
    buffer_load_dwordx4 a[232:235], v90, s[96:99], 0 offen offset:1152
    buffer_load_dwordx4 a[236:239], v90, s[96:99], 0 offen offset:1216
    buffer_load_dwordx4 a[240:243], v91, s[96:99], 0 offen offset:0
    buffer_load_dwordx4 a[244:247], v91, s[96:99], 0 offen offset:64
    buffer_load_dwordx4 a[248:251], v91, s[96:99], 0 offen offset:128
    buffer_load_dwordx4 a[252:255], v91, s[96:99], 0 offen offset:192
    buffer_load_dwordx4 v[128:131], v91, s[96:99], 0 offen offset:256
    buffer_load_dwordx4 v[132:135], v91, s[96:99], 0 offen offset:320
    buffer_load_dwordx4 v[136:139], v91, s[96:99], 0 offen offset:384
    buffer_load_dwordx4 v[140:143], v91, s[96:99], 0 offen offset:448
    buffer_load_dwordx4 v[144:147], v91, s[96:99], 0 offen offset:512
    buffer_load_dwordx4 v[148:151], v91, s[96:99], 0 offen offset:576
    buffer_load_dwordx4 v[152:155], v91, s[96:99], 0 offen offset:640
    buffer_load_dwordx4 v[156:159], v91, s[96:99], 0 offen offset:704
    buffer_load_dwordx4 v[160:163], v91, s[96:99], 0 offen offset:768
    buffer_load_dwordx4 v[164:167], v91, s[96:99], 0 offen offset:832
    buffer_load_dwordx4 v[168:171], v91, s[96:99], 0 offen offset:896
    buffer_load_dwordx4 v[172:175], v91, s[96:99], 0 offen offset:960
    buffer_load_dwordx4 v[176:179], v91, s[96:99], 0 offen offset:1024
    buffer_load_dwordx4 v[180:183], v91, s[96:99], 0 offen offset:1088
    buffer_load_dwordx4 v[184:187], v91, s[96:99], 0 offen offset:1152
    buffer_load_dwordx4 v[188:191], v91, s[96:99], 0 offen offset:1216
    buffer_load_dwordx4 v[124:127], v92, s[96:99], 0 offen offset:1088
    buffer_load_dwordx4 v[192:195], v92, s[96:99], 0 offen offset:1152
    buffer_load_dwordx4 v[196:199], v92, s[96:99], 0 offen offset:1216
    buffer_load_dwordx4 v[200:203], v93, s[96:99], 0 offen offset:1152
    buffer_load_dwordx4 v[204:207], v93, s[96:99], 0 offen offset:1216
    buffer_load_dwordx2 v[208:209], v94, s[96:99], s58 offen offset:0
    buffer_load_dwordx2 v[210:211], v94, s[96:99], s58 offen offset:32
    buffer_load_dwordx2 v[212:213], v94, s[96:99], s58 offen offset:64
    buffer_load_dwordx2 v[214:215], v94, s[96:99], s58 offen offset:96
    buffer_load_dwordx2 v[216:217], v94, s[96:99], s58 offen offset:128
    buffer_load_dwordx2 v[218:219], v94, s[96:99], s58 offen offset:160
    buffer_load_dwordx2 v[220:221], v94, s[96:99], s58 offen offset:192
    buffer_load_dwordx2 v[222:223], v94, s[96:99], s58 offen offset:224
    buffer_load_dwordx2 v[224:225], v95, s[96:99], s58 offen offset:0
    buffer_load_dwordx2 v[226:227], v95, s[96:99], s58 offen offset:32
    buffer_load_dwordx2 v[228:229], v95, s[96:99], s58 offen offset:64
    buffer_load_dwordx2 v[230:231], v95, s[96:99], s58 offen offset:96
    buffer_load_dwordx2 v[232:233], v95, s[96:99], s58 offen offset:128
    buffer_load_dwordx2 v[234:235], v95, s[96:99], s58 offen offset:160
    buffer_load_dwordx2 v[236:237], v95, s[96:99], s58 offen offset:192
    buffer_load_dwordx2 v[238:239], v95, s[96:99], s58 offen offset:224
    buffer_load_dwordx2 v[240:241], v96, s[96:99], s58 offen offset:0
    buffer_load_dwordx2 v[242:243], v96, s[96:99], s58 offen offset:32
    buffer_load_dwordx2 v[244:245], v96, s[96:99], s58 offen offset:64
    buffer_load_dwordx2 v[246:247], v96, s[96:99], s58 offen offset:96
    buffer_load_dwordx2 v[248:249], v96, s[96:99], s58 offen offset:128
    buffer_load_dwordx2 v[250:251], v96, s[96:99], s58 offen offset:160
    buffer_load_dwordx2 v[252:253], v96, s[96:99], s58 offen offset:192
    buffer_load_dwordx2 v[254:255], v96, s[96:99], s58 offen offset:224
    s_mov_b32 s40, 152567808
    s_mov_b32 s37, 0
ch_kv0:
    buffer_load_dword v32, off, s[96:99], s40 sc1
    s_waitcnt vmcnt(0)
    s_add_u32 s37, s37, 1
    s_cmp_gt_u32 s37, 0x40000
    s_cbranch_scc1 ch_end
    v_cmp_gt_u32 vcc, 64, v32
    s_nop 1
    s_cbranch_vccz ch_kv1
    s_sleep 4
    s_branch ch_kv0
ch_kv1:
    buffer_load_dwordx2 v[60:61], v19, s[96:99], s44 offen offset:0
    buffer_load_dwordx2 v[62:63], v19, s[96:99], s44 offen offset:32
    buffer_load_dwordx2 v[64:65], v20, s[96:99], s44 offen offset:0
    buffer_load_dwordx2 v[66:67], v20, s[96:99], s44 offen offset:32
    s_add_u32 s44, s44, 0x80000
    buffer_load_dwordx2 v[68:69], v21, s[96:99], s45 offen offset:0
    buffer_load_dwordx2 v[70:71], v21, s[96:99], s45 offen offset:32
    buffer_load_dwordx2 v[72:73], v21, s[96:99], s45 offen offset:1024
    buffer_load_dwordx2 v[74:75], v21, s[96:99], s45 offen offset:1056
    s_add_u32 s45, s45, 0x40000
    s_mov_b32 s30, 0
    s_mov_b32 s37, 0
    s_branch ch_gotmem
ch_loop:
    s_mul_i32 s60, s30, 90112
    s_add_u32 s60, s60, 146800640
    s_add_u32 s61, s60, 4096
    s_add_u32 s62, s60, 8192
    s_add_u32 s63, s60, 12288
    s_add_u32 s64, s60, 16384
    s_add_u32 s65, s60, 20480
    s_add_u32 s40, s30, 1
    s_lshr_b32 s40, s40, 2
    s_min_u32 s40, s40, 15
    s_lshl_b32 s40, s40, 8
    s_add_u32 s40, s40, 152567808
ch_poll1:
    buffer_load_dwordx4 v[100:103], v6, s[96:99], s60 offen sc1
    buffer_load_dwordx4 v[104:107], v6, s[96:99], s61 offen sc1
    buffer_load_dwordx4 v[108:111], v6, s[96:99], s62 offen sc1
    buffer_load_dwordx4 v[112:115], v6, s[96:99], s63 offen sc1
    buffer_load_dwordx4 v[116:119], v6, s[96:99], s64 offen sc1
    buffer_load_dwordx4 v[120:123], v8, s[96:99], s65 offen sc1
    buffer_load_dword v32, off, s[96:99], s40 sc1
    s_waitcnt vmcnt(0)
    s_add_u32 s37, s37, 1
    s_cmp_gt_u32 s37, 0x40000
    s_cbranch_scc1 ch_end
    v_cmp_gt_u32 s[42:43], 64, v32
    v_min_u32 v1, v103, v107
    v_min3_u32 v1, v1, v111, v115
    v_min3_u32 v1, v1, v119, v123
    v_cmp_ne_u32 vcc, 0x42000000, v1
    s_and_b64 vcc, vcc, s[52:53]
    s_or_b64 vcc, vcc, s[42:43]
    s_cbranch_vccnz ch_poll1
    v_cvt_pk_bf16_f32 v76, v100, v101
    v_cvt_pk_bf16_f32 v77, v102, v104
    v_cvt_pk_bf16_f32 v78, v105, v106
    v_cvt_pk_bf16_f32 v79, v108, v109
    v_cvt_pk_bf16_f32 v80, v110, v112
    v_cvt_pk_bf16_f32 v81, v113, v114
    v_cvt_pk_bf16_f32 v82, v116, v117
    s_mov_b64 exec, s[52:53]
    ds_write_b64 v11, v[76:77] offset:0
    ds_write_b64 v11, v[78:79] offset:8
    ds_write_b64 v11, v[80:81] offset:16
    ds_write_b32 v12, v82
    s_mov_b64 exec, s[54:55]
    v_cvt_pk_bf16_f32 v100, v100, v101
    v_cvt_pk_bf16_f32 v101, v102, v103
    ds_write_b64 v9, v[100:101] offset:0
    v_cvt_pk_bf16_f32 v104, v104, v105
    v_cvt_pk_bf16_f32 v105, v106, v107
    ds_write_b64 v9, v[104:105] offset:48
    v_cvt_pk_bf16_f32 v108, v108, v109
    v_cvt_pk_bf16_f32 v109, v110, v111
    ds_write_b64 v9, v[108:109] offset:96
    v_cvt_pk_bf16_f32 v112, v112, v113
    v_cvt_pk_bf16_f32 v113, v114, v115
    ds_write_b64 v9, v[112:113] offset:144
    v_cvt_pk_bf16_f32 v116, v116, v117
    v_cvt_pk_bf16_f32 v117, v118, v119
    ds_write_b64 v9, v[116:117] offset:192
    v_cvt_pk_bf16_f32 v120, v120, v121
    v_cvt_pk_bf16_f32 v121, v122, v123
    ds_write_b64 v10, v[120:121] offset:0
    s_mov_b64 exec, -1
ch_gotmem:
    s_waitcnt lgkmcnt(0)
    ds_read_b128 v[120:123], v24 offset:16384
    s_barrier
    s_lshr_b32 s16, s6, 1
    s_or_b32 s16, s16, s7
    s_cmp_lg_u32 s16, 0
    s_cbranch_scc1 ch_nofl
    v_mov_b32 v1, s30
    buffer_store_dword v1, off, s[96:99], s47 sc1
ch_nofl:
    ds_read_b128 v[76:79], v5 offset:0
    ds_read_b128 v[80:83], v5 offset:128
    ds_read_b128 v[84:87], v5 offset:256
    ds_read_b128 v[88:91], v5 offset:384
    ds_read_b128 v[92:95], v5 offset:512
    ds_read_b128 v[96:99], v5 offset:640
    ds_read_b128 v[100:103], v5 offset:768
    ds_read_b128 v[104:107], v5 offset:896
    ds_read_b128 v[108:111], v5 offset:1024
    ds_read_b128 v[112:115], v5 offset:1152
    s_add_u32 s38, s30, 1
    s_mul_i32 s48, s38, 90112
    s_add_u32 s48, s48, 146800640
    s_waitcnt lgkmcnt(9)
    v_smfmac_f32_16x16x64_bf16 v[36:39], v[76:79], a[0:7], v2
    v_smfmac_f32_16x16x64_bf16 v[40:43], v[76:79], a[80:87], v2
    v_smfmac_f32_16x16x64_bf16 v[44:47], v[76:79], a[160:167], v2
    v_smfmac_f32_16x16x64_bf16 v[48:51], v[76:79], a[240:247], v2
    s_waitcnt lgkmcnt(8)
    v_smfmac_f32_16x16x64_bf16 v[36:39], v[80:83], a[8:15], v2
    v_smfmac_f32_16x16x64_bf16 v[40:43], v[80:83], a[88:95], v2
    v_smfmac_f32_16x16x64_bf16 v[44:47], v[80:83], a[168:175], v2
    v_smfmac_f32_16x16x64_bf16 v[48:51], v[80:83], a[248:255], v2
    ds_read_b128 v[76:79], v24 offset:33792
    ds_read_b128 v[80:83], v24 offset:34816
    s_waitcnt lgkmcnt(9)
    v_smfmac_f32_16x16x64_bf16 v[36:39], v[84:87], a[16:23], v2
    v_smfmac_f32_16x16x64_bf16 v[40:43], v[84:87], a[96:103], v2
    v_smfmac_f32_16x16x64_bf16 v[44:47], v[84:87], a[176:183], v2
    v_smfmac_f32_16x16x64_bf16 v[48:51], v[84:87], v[128:135], v2
    s_waitcnt lgkmcnt(8)
    v_smfmac_f32_16x16x64_bf16 v[36:39], v[88:91], a[24:31], v2
    v_smfmac_f32_16x16x64_bf16 v[40:43], v[88:91], a[104:111], v2
    v_smfmac_f32_16x16x64_bf16 v[44:47], v[88:91], a[184:191], v2
    v_smfmac_f32_16x16x64_bf16 v[48:51], v[88:91], v[136:143], v2
    ds_read_b128 v[84:87], v24 offset:14336
    ds_read_b128 v[88:91], v24 offset:15360
    s_waitcnt lgkmcnt(9)
    v_smfmac_f32_16x16x64_bf16 v[36:39], v[92:95], a[32:39], v2
    v_smfmac_f32_16x16x64_bf16 v[40:43], v[92:95], a[112:119], v2
    v_smfmac_f32_16x16x64_bf16 v[44:47], v[92:95], a[192:199], v2
    v_smfmac_f32_16x16x64_bf16 v[48:51], v[92:95], v[144:151], v2
    s_waitcnt lgkmcnt(8)
    v_smfmac_f32_16x16x64_bf16 v[36:39], v[96:99], a[40:47], v2
    v_smfmac_f32_16x16x64_bf16 v[40:43], v[96:99], a[120:127], v2
    v_smfmac_f32_16x16x64_bf16 v[44:47], v[96:99], a[200:207], v2
    v_smfmac_f32_16x16x64_bf16 v[48:51], v[96:99], v[152:159], v2
    s_waitcnt lgkmcnt(7)
    v_smfmac_f32_16x16x64_bf16 v[36:39], v[100:103], a[48:55], v2
    v_smfmac_f32_16x16x64_bf16 v[40:43], v[100:103], a[128:135], v2
    v_smfmac_f32_16x16x64_bf16 v[44:47], v[100:103], a[208:215], v2
    v_smfmac_f32_16x16x64_bf16 v[48:51], v[100:103], v[160:167], v2
    s_waitcnt lgkmcnt(6)
    v_smfmac_f32_16x16x64_bf16 v[36:39], v[104:107], a[56:63], v2
    v_smfmac_f32_16x16x64_bf16 v[40:43], v[104:107], a[136:143], v2
    v_smfmac_f32_16x16x64_bf16 v[44:47], v[104:107], a[216:223], v2
    v_smfmac_f32_16x16x64_bf16 v[48:51], v[104:107], v[168:175], v2
    s_waitcnt lgkmcnt(5)
    v_smfmac_f32_16x16x64_bf16 v[36:39], v[108:111], a[64:71], v2
    v_smfmac_f32_16x16x64_bf16 v[40:43], v[108:111], a[144:151], v2
    v_smfmac_f32_16x16x64_bf16 v[44:47], v[108:111], a[224:231], v2
    v_smfmac_f32_16x16x64_bf16 v[48:51], v[108:111], v[176:183], v2
    s_waitcnt lgkmcnt(4)
    v_smfmac_f32_16x16x64_bf16 v[36:39], v[112:115], a[72:79], v2
    v_smfmac_f32_16x16x64_bf16 v[40:43], v[112:115], a[152:159], v2
    v_smfmac_f32_16x16x64_bf16 v[44:47], v[112:115], a[232:239], v2
    v_smfmac_f32_16x16x64_bf16 v[48:51], v[112:115], v[184:191], v2
    v_smfmac_f32_16x16x64_bf16 v[52:55], v[112:115], v[192:199], v2
    v_smfmac_f32_16x16x64_bf16 v[56:59], v[112:115], v[200:207], v2
    ds_read_b128 v[112:115], v24 offset:31744
    ds_read_b128 v[116:119], v24 offset:32768
    v_add_f32 v36, v36, v38
    v_add_f32 v37, v37, v39
    v_cvt_pk_bf16_f32 v36, v36, v37
    ds_write_b16 v25, v36 offset:0
    ds_write_b16_d16_hi v25, v36 offset:16
    v_add_f32 v40, v40, v42
    v_add_f32 v41, v41, v43
    v_cvt_pk_bf16_f32 v40, v40, v41
    ds_write_b16 v25, v40 offset:8
    ds_write_b16_d16_hi v25, v40 offset:24
    v_add_f32 v44, v44, v46
    v_add_f32 v45, v45, v47
    v_cvt_pk_bf16_f32 v44, v44, v45
    ds_write_b16 v25, v44 offset:512
    ds_write_b16_d16_hi v25, v44 offset:528
    v_add_f32 v48, v48, v50
    v_add_f32 v49, v49, v51
    v_cvt_pk_bf16_f32 v48, v48, v49
    ds_write_b16 v25, v48 offset:520
    ds_write_b16_d16_hi v25, v48 offset:536
    s_waitcnt lgkmcnt(10)
    ds_read_b128 v[36:39], v13 offset:5120
    ds_read_b128 v[44:47], v13 offset:5632
    v_smfmac_f32_16x16x64_bf16 v[52:55], v[108:111], v[120:127], v2
    v_smfmac_f32_16x16x64_bf16 v[56:59], v[108:111], v[76:83], v2
    ds_read_b128 v[76:79], v24 offset:12288
    ds_read_b128 v[80:83], v24 offset:13312
    v_smfmac_f32_16x16x64_bf16 v[52:55], v[104:107], v[84:91], v2
    s_waitcnt vmcnt(0)
    s_waitcnt lgkmcnt(3)
    v_mfma_f32_16x16x32_bf16 v[40:43], v[60:63], v[36:39], 0
    v_mfma_f32_16x16x32_bf16 v[48:51], v[64:67], v[36:39], 0
    s_waitcnt lgkmcnt(2)
    v_mfma_f32_16x16x32_bf16 v[32:35], v[44:47], v[36:39], 0
    v_smfmac_f32_16x16x64_bf16 v[56:59], v[104:107], v[112:119], v2
    ds_read_b128 v[84:87], v24 offset:29696
    ds_read_b128 v[88:91], v24 offset:30720
    ds_read_b128 v[104:107], v24 offset:10240
    ds_read_b128 v[108:111], v24 offset:11264
    s_waitcnt lgkmcnt(4)
    v_smfmac_f32_16x16x64_bf16 v[52:55], v[100:103], v[76:83], v2
    ds_read_b128 v[76:79], v24 offset:27648
    ds_read_b128 v[80:83], v24 offset:28672
    ds_read_b128 v[92:95], v5 offset:512
    ds_read_b128 v[112:115], v24 offset:8192
    ds_read_b128 v[116:119], v24 offset:9216
    s_cmp_lg_u32 s6, 0
    s_cbranch_scc1 ch_nokm
    buffer_store_dwordx2 v[44:45], v22, s[96:99], s46 offen offset:0 sc1
    buffer_store_dwordx2 v[46:47], v22, s[96:99], s46 offen offset:32 sc1
ch_nokm:
    s_nop 1
    ds_write_b128 v13, v[40:43]
    ds_write_b128 v13, v[48:51] offset:512
    ds_write_b64 v14, v[32:33]
    s_waitcnt lgkmcnt(10)
    v_smfmac_f32_16x16x64_bf16 v[56:59], v[100:103], v[84:91], v2
    ds_read_b128 v[84:87], v24 offset:25600
    ds_read_b128 v[88:91], v24 offset:26624
    ds_read_b128 v[100:103], v5 offset:384
    s_waitcnt lgkmcnt(11)
    v_smfmac_f32_16x16x64_bf16 v[52:55], v[96:99], v[104:111], v2
    ds_read_b128 v[104:107], v24 offset:6144
    ds_read_b128 v[108:111], v24 offset:7168
    s_waitcnt lgkmcnt(5)
    s_barrier
    ds_read_b128 v[36:39], v15 offset:0
    ds_read_b32 v34, v16 offset:0
    ds_read_b128 v[40:43], v15 offset:1024
    ds_read_b32 v35, v16 offset:256
    ds_read_b128 v[44:47], v15 offset:2048
    ds_read_b32 v28, v16 offset:512
    ds_read_b128 v[48:51], v15 offset:3072
    ds_read_b32 v30, v16 offset:768
    v_smfmac_f32_16x16x64_bf16 v[56:59], v[96:99], v[76:83], v2
    v_smfmac_f32_16x16x64_bf16 v[52:55], v[92:95], v[112:119], v2
    s_waitcnt lgkmcnt(11)
    v_smfmac_f32_16x16x64_bf16 v[56:59], v[92:95], v[84:91], v2
    ds_read_b128 v[76:79], v24 offset:23552
    ds_read_b128 v[80:83], v24 offset:24576
    s_waitcnt lgkmcnt(6)
    v_add_f32 v36, v36, v40
    v_add_f32 v37, v37, v41
    v_add_f32 v38, v38, v42
    v_add_f32 v39, v39, v43
    v_smfmac_f32_16x16x64_bf16 v[52:55], v[100:103], v[104:111], v2
    ds_read_b128 v[84:87], v5 offset:256
    ds_read_b128 v[88:91], v24 offset:4096
    ds_read_b128 v[92:95], v24 offset:5120
    ds_read_b128 v[104:107], v24 offset:21504
    ds_read_b128 v[108:111], v24 offset:22528
    v_add_f32 v34, v34, v35
    s_waitcnt lgkmcnt(7)
    v_add_f32 v44, v44, v48
    v_add_f32 v45, v45, v49
    v_add_f32 v46, v46, v50
    s_waitcnt lgkmcnt(5)
    v_smfmac_f32_16x16x64_bf16 v[56:59], v[100:103], v[76:83], v2
    ds_read_b128 v[76:79], v5 offset:128
    ds_read_b128 v[96:99], v24 offset:2048
    ds_read_b128 v[100:103], v24 offset:3072
    ds_read_b128 v[112:115], v24 offset:19456
    ds_read_b128 v[116:119], v24 offset:20480
    v_add_f32 v47, v47, v51
    v_add_f32 v28, v28, v30
    v_add_f32 v36, v36, v44
    v_add_f32 v37, v37, v45
    s_waitcnt lgkmcnt(7)
    v_smfmac_f32_16x16x64_bf16 v[52:55], v[84:87], v[88:95], v2
    ds_read_b128 v[80:83], v5 offset:0
    ds_read_b128 v[88:91], v24 offset:0
    ds_read_b128 v[92:95], v24 offset:1024
    v_add_f32 v38, v38, v46
    v_add_f32 v39, v39, v47
    v_add_f32 v34, v34, v28
    s_mov_b32 s35, 0x3db504f3
    s_mov_b32 s34, 0x3fb8aa3b
    v_cvt_pk_bf16_f32 v36, v36, v36
    s_waitcnt lgkmcnt(8)
    v_smfmac_f32_16x16x64_bf16 v[56:59], v[84:87], v[104:111], v2
    ds_read_b128 v[104:107], v24 offset:17408
    ds_read_b128 v[108:111], v24 offset:18432
    v_cvt_pk_bf16_f32 v37, v37, v37
    v_cvt_pk_bf16_f32 v38, v38, v38
    v_cvt_pk_bf16_f32 v39, v39, v39
    v_cvt_pk_bf16_f32 v34, v34, v34
    s_waitcnt lgkmcnt(7)
    v_smfmac_f32_16x16x64_bf16 v[52:55], v[76:79], v[96:103], v2
    v_and_b32 v36, 0xffff0000, v36
    v_and_b32 v37, 0xffff0000, v37
    v_and_b32 v38, 0xffff0000, v38
    v_and_b32 v39, 0xffff0000, v39
    s_waitcnt lgkmcnt(5)
    v_smfmac_f32_16x16x64_bf16 v[56:59], v[76:79], v[112:119], v2
    v_and_b32 v34, 0xffff0000, v34
    v_mul_f32 v36, s35, v36
    v_mul_f32 v37, s35, v37
    v_mul_f32 v38, s35, v38
    s_waitcnt lgkmcnt(2)
    v_smfmac_f32_16x16x64_bf16 v[52:55], v[80:83], v[88:95], v2
    v_mul_f32 v39, s35, v39
    v_mul_f32 v34, s35, v34
    v_cvt_pk_bf16_f32 v36, v36, v36
    v_cvt_pk_bf16_f32 v37, v37, v37
    s_waitcnt lgkmcnt(0)
    v_smfmac_f32_16x16x64_bf16 v[56:59], v[80:83], v[104:111], v2
    v_cvt_pk_bf16_f32 v38, v38, v38
    v_cvt_pk_bf16_f32 v39, v39, v39
    v_cvt_pk_bf16_f32 v34, v34, v34
    v_and_b32 v36, 0xffff0000, v36
    v_and_b32 v37, 0xffff0000, v37
    v_and_b32 v38, 0xffff0000, v38
    v_and_b32 v39, 0xffff0000, v39
    v_and_b32 v34, 0xffff0000, v34
    v_max3_f32 v32, v36, v37, v38
    v_max3_f32 v32, v32, v39, v34
    s_nop 1
    v_max_f32_dpp v32, v32, v32 row_ror:8 row_mask:0xf bank_mask:0xf
    v_mov_b32 v33, v32
    s_nop 1
    v_permlane32_swap_b32 v32, v33
    s_nop 1
    v_max_f32 v32, v32, v33
    v_mov_b32 v33, v32
    s_nop 1
    v_permlane16_swap_b32 v32, v33
    s_nop 1
    v_max_f32 v32, v32, v33
    v_sub_f32 v36, v36, v32
    v_sub_f32 v37, v37, v32
    v_sub_f32 v38, v38, v32
    v_sub_f32 v39, v39, v32
    v_sub_f32 v34, v34, v32
    v_mul_f32 v36, s34, v36
    v_mul_f32 v37, s34, v37
    v_mul_f32 v38, s34, v38
    v_mul_f32 v39, s34, v39
    v_mul_f32 v34, s34, v34
    v_exp_f32 v36, v36
    v_exp_f32 v37, v37
    v_exp_f32 v38, v38
    v_exp_f32 v39, v39
    v_exp_f32 v34, v34
    v_add_f32 v32, v36, v37
    v_add_f32 v33, v38, v39
    v_add_f32 v32, v32, v34
    v_add_f32 v32, v32, v33
    s_nop 1
    v_add_f32_dpp v32, v32, v32 row_ror:8 row_mask:0xf bank_mask:0xf
    v_mov_b32 v33, v32
    s_nop 1
    v_permlane32_swap_b32 v32, v33
    s_nop 1
    v_add_f32 v32, v32, v33
    v_mov_b32 v33, v32
    s_nop 1
    v_permlane16_swap_b32 v32, v33
    s_nop 1
    v_add_f32 v32, v32, v33
    v_rcp_f32 v32, v32
    v_add_f32 v52, v52, v54
    v_add_f32 v53, v53, v55
    v_add_f32 v56, v56, v58
    v_add_f32 v57, v57, v59
    v_cvt_pk_bf16_f32 v28, v52, v53
    v_cvt_pk_bf16_f32 v30, v56, v57
    s_cmp_lg_u32 s6, 1
    s_cbranch_scc1 ch_novm
    buffer_store_dword v28, v23, s[96:99], s46 offen offset:0 sc1
    buffer_store_dword v30, v23, s[96:99], s46 offen offset:256 sc1
ch_novm:
    s_cmp_eq_u32 s30, 63
    s_cbranch_scc1 ch_fin
    v_mul_f32 v36, v36, v32
    v_mul_f32 v37, v37, v32
    v_mul_f32 v38, v38, v32
    v_mul_f32 v39, v39, v32
    v_mul_f32 v34, v34, v32
    v_cvt_pk_bf16_f32 v40, v36, v37
    v_cvt_pk_bf16_f32 v41, v38, v39
    v_mov_b32_dpp v33, v34 row_ror:8 row_mask:0xf bank_mask:0xf
    v_mov_b32_dpp v42, v40 row_ror:8 row_mask:0xf bank_mask:0xf
    v_mov_b32_dpp v43, v41 row_ror:8 row_mask:0xf bank_mask:0xf
    v_cvt_pk_bf16_f32 v26, v34, v33
    s_nop 0
    v_mfma_f32_16x16x32_bf16 v[44:47], v[68:71], v[40:43], 0
    v_mfma_f32_16x16x32_bf16 v[48:51], v[72:75], v[40:43], 0
    v_mfma_f32_16x16x16_bf16 v[44:47], v[28:29], v[26:27], v[44:47]
    v_mfma_f32_16x16x16_bf16 v[48:51], v[30:31], v[26:27], v[48:51]
    buffer_load_dwordx2 v[60:61], v19, s[96:99], s44 offen offset:0
    buffer_load_dwordx2 v[62:63], v19, s[96:99], s44 offen offset:32
    buffer_load_dwordx2 v[64:65], v20, s[96:99], s44 offen offset:0
    buffer_load_dwordx2 v[66:67], v20, s[96:99], s44 offen offset:32
    s_add_u32 s44, s44, 0x80000
    s_add_u32 s46, s46, 65536
    v_cndmask_b32 v52, 0, 1.0, s[56:57]
    v_cndmask_b32 v53, 0, 1.0, s[56:57]
    v_cndmask_b32 v54, 0, 1.0, s[56:57]
    v_cndmask_b32 v55, 0, 1.0, s[56:57]
    v_cvt_pk_bf16_f32 v44, v44, v45
    v_cvt_pk_bf16_f32 v45, v46, v47
    v_cvt_pk_bf16_f32 v46, v48, v49
    v_cvt_pk_bf16_f32 v47, v50, v51
    ds_write_b128 v17, v[44:47]
    buffer_load_dwordx2 v[68:69], v21, s[96:99], s45 offen offset:0
    buffer_load_dwordx2 v[70:71], v21, s[96:99], s45 offen offset:32
    buffer_load_dwordx2 v[72:73], v21, s[96:99], s45 offen offset:1024
    buffer_load_dwordx2 v[74:75], v21, s[96:99], s45 offen offset:1056
    s_add_u32 s45, s45, 0x40000
    s_waitcnt lgkmcnt(0)
    s_barrier
    ds_read_b128 v[36:39], v18 offset:0
    ds_read_b128 v[40:43], v18 offset:1024
    ds_read_b128 v[44:47], v18 offset:2048
    ds_read_b128 v[48:51], v18 offset:3072
    s_waitcnt lgkmcnt(3)
    v_mfma_f32_16x16x32_bf16 v[76:79], v[36:39], v[208:211], v[52:55]
    s_waitcnt lgkmcnt(2)
    v_mfma_f32_16x16x32_bf16 v[76:79], v[40:43], v[212:215], v[76:79]
    s_waitcnt lgkmcnt(1)
    v_mfma_f32_16x16x32_bf16 v[76:79], v[44:47], v[216:219], v[76:79]
    s_waitcnt lgkmcnt(0)
    v_mfma_f32_16x16x32_bf16 v[76:79], v[48:51], v[220:223], v[76:79]
    v_mfma_f32_16x16x32_bf16 v[80:83], v[36:39], v[224:227], v[52:55]
    v_mfma_f32_16x16x32_bf16 v[80:83], v[40:43], v[228:231], v[80:83]
    v_mfma_f32_16x16x32_bf16 v[80:83], v[44:47], v[232:235], v[80:83]
    v_mfma_f32_16x16x32_bf16 v[80:83], v[48:51], v[236:239], v[80:83]
    v_mfma_f32_16x16x32_bf16 v[84:87], v[36:39], v[240:243], v[52:55]
    v_mfma_f32_16x16x32_bf16 v[84:87], v[40:43], v[244:247], v[84:87]
    v_mfma_f32_16x16x32_bf16 v[84:87], v[44:47], v[248:251], v[84:87]
    v_mfma_f32_16x16x32_bf16 v[84:87], v[48:51], v[252:255], v[84:87]
    s_nop 3
    v_permlane32_swap_b32 v76, v80
    v_permlane32_swap_b32 v77, v81
    v_permlane32_swap_b32 v78, v82
    v_permlane32_swap_b32 v79, v83
    buffer_atomic_add_f32 v76, v0, s[96:99], s48 offen offset:0 sc1
    buffer_atomic_add_f32 v77, v0, s[96:99], s48 offen offset:256 sc1
    buffer_atomic_add_f32 v78, v0, s[96:99], s48 offen offset:512 sc1
    buffer_atomic_add_f32 v79, v0, s[96:99], s48 offen offset:768 sc1
    v_permlane32_swap_b32 v84, v86
    v_permlane32_swap_b32 v85, v87
    buffer_atomic_add_f32 v84, v3, s[96:99], s48 offen offset:0 sc1
    buffer_atomic_add_f32 v85, v3, s[96:99], s48 offen offset:256 sc1
    v_mov_b32 v36, 0
    v_mov_b32 v37, 0
    v_mov_b32 v38, 0
    v_mov_b32 v39, 0
    v_mov_b32 v40, 0
    v_mov_b32 v41, 0
    v_mov_b32 v42, 0
    v_mov_b32 v43, 0
    v_mov_b32 v44, 0
    v_mov_b32 v45, 0
    v_mov_b32 v46, 0
    v_mov_b32 v47, 0
    v_mov_b32 v48, 0
    v_mov_b32 v49, 0
    v_mov_b32 v50, 0
    v_mov_b32 v51, 0
    v_mov_b32 v52, 0
    v_mov_b32 v53, 0
    v_mov_b32 v54, 0
    v_mov_b32 v55, 0
    v_mov_b32 v56, 0
    v_mov_b32 v57, 0
    v_mov_b32 v58, 0
    v_mov_b32 v59, 0
    s_waitcnt vmcnt(0)
    s_mov_b32 s30, s38
    s_cmp_lt_u32 s30, 63
    s_cbranch_scc1 ch_loop
    s_cmp_lt_u32 s6, 2
    s_cbranch_scc1 ch_loop
    s_branch ch_end
ch_fin:
    s_waitcnt vmcnt(0)
    s_barrier
    v_mov_b32 v1, 64
    buffer_store_dword v1, off, s[96:99], s47 sc1
ch_end:
    s_endpgm
wk_entry:
    s_cmp_ge_u32 s2, 3165
    s_cbranch_scc1 wk_end
    s_load_dwordx2 s[96:97], s[0:1], 96
    s_waitcnt lgkmcnt(0)
    s_mov_b32 s98, 268435456
    s_mov_b32 s99, 0x00020000
    v_lshrrev_b32 v1, 6, v0
    v_and_b32 v2, 63, v0
    s_nop 0
    v_readfirstlane_b32 s7, v1
    s_sub_u32 s2, s2, 128
    s_cmp_ge_u32 s2, 1024
    s_cbranch_scc1 wk_q
    s_lshr_b32 s4, s2, 6
    s_and_b32 s5, s2, 31
    s_lshl_b32 s36, s4, 8
    s_add_u32 s36, s36, 152567808
    s_bitcmp1_b32 s2, 5
    s_cbranch_scc1 g1_p1
    s_add_u32 s5, s5, 32
    s_branch g1_p0
wk_q:
    s_sub_u32 s2, s2, 1024
    s_cmp_lt_u32 s2, 40
    s_cbranch_scc1 wk_t
    s_sub_u32 s2, s2, 40
    s_cmp_ge_u32 s2, 512
    s_cbranch_scc1 wk_b
    s_lshr_b32 s4, s2, 5
    s_and_b32 s5, s2, 31
    s_lshl_b32 s36, s4, 8
    s_add_u32 s36, s36, 152571904
    s_branch g1_p0
wk_b:
    s_sub_u32 s2, s2, 512
    s_cmp_ge_u32 s2, 240
    s_cbranch_scc1 wk_ab
    s_and_b32 s4, s2, 15
    s_lshr_b32 s5, s2, 4
    s_mov_b32 s36, 152576000
    v_mov_b32 v250, 152576512
    v_mov_b32 v251, 40
    s_cmp_lg_u32 s7, 0
    s_cbranch_scc1 wt1_d
    s_mov_b32 s37, 0
wt1_l:
    buffer_load_dword v252, v250, s[96:99], 0 offen sc1
    s_waitcnt vmcnt(0)
    v_cmp_gt_u32 vcc, v251, v252
    s_nop 1
    s_cbranch_vccz wt1_d
    s_add_u32 s37, s37, 1
    s_cmp_gt_u32 s37, 0x20000
    s_cbranch_scc1 wt1_d
    s_sleep 16
    s_branch wt1_l
wt1_d:
    s_barrier
    s_branch g1_p2
wk_t:
    s_cmp_ge_u32 s2, 30
    s_cbranch_scc1 wk_t1
    s_load_dwordx2 s[8:9], s[0:1], 64
    s_waitcnt lgkmcnt(0)
    s_mov_b32 s10, 2457600
    s_mov_b32 s11, 0x00020000
    s_mov_b32 s13, 3840
    s_mov_b32 s14, 23068672
    s_branch wk_tg
wk_t1:
    s_sub_u32 s2, s2, 30
    s_load_dwordx2 s[8:9], s[0:1], 72
    s_waitcnt lgkmcnt(0)
    s_mov_b32 s10, 819200
    s_mov_b32 s11, 0x00020000
    s_mov_b32 s13, 1280
    s_mov_b32 s14, 26214400
wk_tg:
    s_mul_i32 s12, s2, 81920
    s_add_u32 s12, s12, s14
    s_lshl_b32 s6, s2, 7
    s_lshl_b32 s15, s13, 4
    s_mov_b32 s36, 152576512
    v_lshrrev_b32 v1, 4, v0
    v_and_b32 v2, 15, v0
    v_mul_lo_u32 v3, v1, s13
    v_lshl_add_u32 v3, v2, 3, v3
    v_add_u32 v3, s6, v3
    v_mul_u32_u24 v4, 136, v1
    v_lshl_add_u32 v4, v2, 3, v4
    v_add_u32 v5, 43520, v4
    buffer_load_dwordx2 v[8:9], v3, s[8:11], 0 offen
    v_add_u32 v3, s15, v3
    buffer_load_dwordx2 v[10:11], v3, s[8:11], 0 offen
    v_add_u32 v3, s15, v3
    buffer_load_dwordx2 v[12:13], v3, s[8:11], 0 offen
    v_add_u32 v3, s15, v3
    buffer_load_dwordx2 v[14:15], v3, s[8:11], 0 offen
    v_add_u32 v3, s15, v3
    buffer_load_dwordx2 v[16:17], v3, s[8:11], 0 offen
    v_add_u32 v3, s15, v3
    buffer_load_dwordx2 v[18:19], v3, s[8:11], 0 offen
    v_add_u32 v3, s15, v3
    buffer_load_dwordx2 v[20:21], v3, s[8:11], 0 offen
    v_add_u32 v3, s15, v3
    buffer_load_dwordx2 v[22:23], v3, s[8:11], 0 offen
    v_add_u32 v3, s15, v3
    buffer_load_dwordx2 v[24:25], v3, s[8:11], 0 offen
    v_add_u32 v3, s15, v3
    buffer_load_dwordx2 v[26:27], v3, s[8:11], 0 offen
    v_add_u32 v3, s15, v3
    buffer_load_dwordx2 v[28:29], v3, s[8:11], 0 offen
    v_add_u32 v3, s15, v3
    buffer_load_dwordx2 v[30:31], v3, s[8:11], 0 offen
    v_add_u32 v3, s15, v3
    buffer_load_dwordx2 v[32:33], v3, s[8:11], 0 offen
    v_add_u32 v3, s15, v3
    buffer_load_dwordx2 v[34:35], v3, s[8:11], 0 offen
    v_add_u32 v3, s15, v3
    buffer_load_dwordx2 v[36:37], v3, s[8:11], 0 offen
    v_add_u32 v3, s15, v3
    buffer_load_dwordx2 v[38:39], v3, s[8:11], 0 offen
    v_add_u32 v3, s15, v3
    buffer_load_dwordx2 v[40:41], v3, s[8:11], 0 offen
    v_add_u32 v3, s15, v3
    buffer_load_dwordx2 v[42:43], v3, s[8:11], 0 offen
    v_add_u32 v3, s15, v3
    buffer_load_dwordx2 v[44:45], v3, s[8:11], 0 offen
    v_add_u32 v3, s15, v3
    buffer_load_dwordx2 v[46:47], v3, s[8:11], 0 offen
    v_add_u32 v3, s15, v3
    buffer_load_dwordx2 v[48:49], v3, s[8:11], 0 offen
    v_add_u32 v3, s15, v3
    buffer_load_dwordx2 v[50:51], v3, s[8:11], 0 offen
    v_add_u32 v3, s15, v3
    buffer_load_dwordx2 v[52:53], v3, s[8:11], 0 offen
    v_add_u32 v3, s15, v3
    buffer_load_dwordx2 v[54:55], v3, s[8:11], 0 offen
    v_add_u32 v3, s15, v3
    buffer_load_dwordx2 v[56:57], v3, s[8:11], 0 offen
    v_add_u32 v3, s15, v3
    buffer_load_dwordx2 v[58:59], v3, s[8:11], 0 offen
    v_add_u32 v3, s15, v3
    buffer_load_dwordx2 v[60:61], v3, s[8:11], 0 offen
    v_add_u32 v3, s15, v3
    buffer_load_dwordx2 v[62:63], v3, s[8:11], 0 offen
    v_add_u32 v3, s15, v3
    buffer_load_dwordx2 v[64:65], v3, s[8:11], 0 offen
    v_add_u32 v3, s15, v3
    buffer_load_dwordx2 v[66:67], v3, s[8:11], 0 offen
    v_add_u32 v3, s15, v3
    buffer_load_dwordx2 v[68:69], v3, s[8:11], 0 offen
    v_add_u32 v3, s15, v3
    buffer_load_dwordx2 v[70:71], v3, s[8:11], 0 offen
    v_add_u32 v3, s15, v3
    buffer_load_dwordx2 v[72:73], v3, s[8:11], 0 offen
    v_add_u32 v3, s15, v3
    buffer_load_dwordx2 v[74:75], v3, s[8:11], 0 offen
    v_add_u32 v3, s15, v3
    buffer_load_dwordx2 v[76:77], v3, s[8:11], 0 offen
    v_add_u32 v3, s15, v3
    buffer_load_dwordx2 v[78:79], v3, s[8:11], 0 offen
    v_add_u32 v3, s15, v3
    buffer_load_dwordx2 v[80:81], v3, s[8:11], 0 offen
    v_add_u32 v3, s15, v3
    buffer_load_dwordx2 v[82:83], v3, s[8:11], 0 offen
    v_add_u32 v3, s15, v3
    buffer_load_dwordx2 v[84:85], v3, s[8:11], 0 offen
    v_add_u32 v3, s15, v3
    buffer_load_dwordx2 v[86:87], v3, s[8:11], 0 offen
    v_add_u32 v3, s15, v3
    s_waitcnt vmcnt(39)
    ds_write_b64 v4, v[8:9] offset:0
    s_waitcnt vmcnt(38)
    ds_write_b64 v4, v[10:11] offset:2176
    s_waitcnt vmcnt(37)
    ds_write_b64 v4, v[12:13] offset:4352
    s_waitcnt vmcnt(36)
    ds_write_b64 v4, v[14:15] offset:6528
    s_waitcnt vmcnt(35)
    ds_write_b64 v4, v[16:17] offset:8704
    s_waitcnt vmcnt(34)
    ds_write_b64 v4, v[18:19] offset:10880
    s_waitcnt vmcnt(33)
    ds_write_b64 v4, v[20:21] offset:13056
    s_waitcnt vmcnt(32)
    ds_write_b64 v4, v[22:23] offset:15232
    s_waitcnt vmcnt(31)
    ds_write_b64 v4, v[24:25] offset:17408
    s_waitcnt vmcnt(30)
    ds_write_b64 v4, v[26:27] offset:19584
    s_waitcnt vmcnt(29)
    ds_write_b64 v4, v[28:29] offset:21760
    s_waitcnt vmcnt(28)
    ds_write_b64 v4, v[30:31] offset:23936
    s_waitcnt vmcnt(27)
    ds_write_b64 v4, v[32:33] offset:26112
    s_waitcnt vmcnt(26)
    ds_write_b64 v4, v[34:35] offset:28288
    s_waitcnt vmcnt(25)
    ds_write_b64 v4, v[36:37] offset:30464
    s_waitcnt vmcnt(24)
    ds_write_b64 v4, v[38:39] offset:32640
    s_waitcnt vmcnt(23)
    ds_write_b64 v4, v[40:41] offset:34816
    s_waitcnt vmcnt(22)
    ds_write_b64 v4, v[42:43] offset:36992
    s_waitcnt vmcnt(21)
    ds_write_b64 v4, v[44:45] offset:39168
    s_waitcnt vmcnt(20)
    ds_write_b64 v4, v[46:47] offset:41344
    s_waitcnt vmcnt(19)
    ds_write_b64 v5, v[48:49] offset:0
    s_waitcnt vmcnt(18)
    ds_write_b64 v5, v[50:51] offset:2176
    s_waitcnt vmcnt(17)
    ds_write_b64 v5, v[52:53] offset:4352
    s_waitcnt vmcnt(16)
    ds_write_b64 v5, v[54:55] offset:6528
    s_waitcnt vmcnt(15)
    ds_write_b64 v5, v[56:57] offset:8704
    s_waitcnt vmcnt(14)
    ds_write_b64 v5, v[58:59] offset:10880
    s_waitcnt vmcnt(13)
    ds_write_b64 v5, v[60:61] offset:13056
    s_waitcnt vmcnt(12)
    ds_write_b64 v5, v[62:63] offset:15232
    s_waitcnt vmcnt(11)
    ds_write_b64 v5, v[64:65] offset:17408
    s_waitcnt vmcnt(10)
    ds_write_b64 v5, v[66:67] offset:19584
    s_waitcnt vmcnt(9)
    ds_write_b64 v5, v[68:69] offset:21760
    s_waitcnt vmcnt(8)
    ds_write_b64 v5, v[70:71] offset:23936
    s_waitcnt vmcnt(7)
    ds_write_b64 v5, v[72:73] offset:26112
    s_waitcnt vmcnt(6)
    ds_write_b64 v5, v[74:75] offset:28288
    s_waitcnt vmcnt(5)
    ds_write_b64 v5, v[76:77] offset:30464
    s_waitcnt vmcnt(4)
    ds_write_b64 v5, v[78:79] offset:32640
    s_waitcnt vmcnt(3)
    ds_write_b64 v5, v[80:81] offset:34816
    s_waitcnt vmcnt(2)
    ds_write_b64 v5, v[82:83] offset:36992
    s_waitcnt vmcnt(1)
    ds_write_b64 v5, v[84:85] offset:39168
    s_waitcnt vmcnt(0)
    ds_write_b64 v5, v[86:87] offset:41344
    s_waitcnt lgkmcnt(0)
    s_barrier
    v_mul_u32_u24 v4, 544, v2
    v_lshl_add_u32 v4, v1, 1, v4
    v_add_u32 v5, 43520, v4
    v_mul_u32_u24 v200, 1280, v1
    v_lshl_add_u32 v200, v2, 3, v200
    v_add_u32 v200, s12, v200
    v_add_u32 v201, 20480, v200
    v_add_u32 v202, 20480, v201
    v_add_u32 v203, 20480, v202
    ds_read_u16 v8, v4 offset:0
    ds_read_u16 v10, v4 offset:136
    ds_read_u16 v9, v4 offset:272
    ds_read_u16 v11, v4 offset:408
    ds_read_u16 v12, v4 offset:32
    ds_read_u16 v14, v4 offset:168
    ds_read_u16 v13, v4 offset:304
    ds_read_u16 v15, v4 offset:440
    ds_read_u16 v16, v4 offset:64
    ds_read_u16 v18, v4 offset:200
    ds_read_u16 v17, v4 offset:336
    ds_read_u16 v19, v4 offset:472
    ds_read_u16 v20, v4 offset:96
    ds_read_u16 v22, v4 offset:232
    ds_read_u16 v21, v4 offset:368
    ds_read_u16 v23, v4 offset:504
    s_waitcnt lgkmcnt(12)
    v_lshl_or_b32 v8, v10, 16, v8
    v_lshl_or_b32 v9, v11, 16, v9
    buffer_store_dwordx2 v[8:9], v200, s[96:99], 0 offen offset:0 sc1
    s_waitcnt lgkmcnt(8)
    v_lshl_or_b32 v12, v14, 16, v12
    v_lshl_or_b32 v13, v15, 16, v13
    buffer_store_dwordx2 v[12:13], v201, s[96:99], 0 offen offset:0 sc1
    s_waitcnt lgkmcnt(4)
    v_lshl_or_b32 v16, v18, 16, v16
    v_lshl_or_b32 v17, v19, 16, v17
    buffer_store_dwordx2 v[16:17], v202, s[96:99], 0 offen offset:0 sc1
    s_waitcnt lgkmcnt(0)
    v_lshl_or_b32 v20, v22, 16, v20
    v_lshl_or_b32 v21, v23, 16, v21
    buffer_store_dwordx2 v[20:21], v203, s[96:99], 0 offen offset:0 sc1
    ds_read_u16 v24, v4 offset:8704
    ds_read_u16 v26, v4 offset:8840
    ds_read_u16 v25, v4 offset:8976
    ds_read_u16 v27, v4 offset:9112
    ds_read_u16 v28, v4 offset:8736
    ds_read_u16 v30, v4 offset:8872
    ds_read_u16 v29, v4 offset:9008
    ds_read_u16 v31, v4 offset:9144
    ds_read_u16 v32, v4 offset:8768
    ds_read_u16 v34, v4 offset:8904
    ds_read_u16 v33, v4 offset:9040
    ds_read_u16 v35, v4 offset:9176
    ds_read_u16 v36, v4 offset:8800
    ds_read_u16 v38, v4 offset:8936
    ds_read_u16 v37, v4 offset:9072
    ds_read_u16 v39, v4 offset:9208
    s_waitcnt lgkmcnt(12)
    v_lshl_or_b32 v24, v26, 16, v24
    v_lshl_or_b32 v25, v27, 16, v25
    buffer_store_dwordx2 v[24:25], v200, s[96:99], 0 offen offset:128 sc1
    s_waitcnt lgkmcnt(8)
    v_lshl_or_b32 v28, v30, 16, v28
    v_lshl_or_b32 v29, v31, 16, v29
    buffer_store_dwordx2 v[28:29], v201, s[96:99], 0 offen offset:128 sc1
    s_waitcnt lgkmcnt(4)
    v_lshl_or_b32 v32, v34, 16, v32
    v_lshl_or_b32 v33, v35, 16, v33
    buffer_store_dwordx2 v[32:33], v202, s[96:99], 0 offen offset:128 sc1
    s_waitcnt lgkmcnt(0)
    v_lshl_or_b32 v36, v38, 16, v36
    v_lshl_or_b32 v37, v39, 16, v37
    buffer_store_dwordx2 v[36:37], v203, s[96:99], 0 offen offset:128 sc1
    ds_read_u16 v40, v4 offset:17408
    ds_read_u16 v42, v4 offset:17544
    ds_read_u16 v41, v4 offset:17680
    ds_read_u16 v43, v4 offset:17816
    ds_read_u16 v44, v4 offset:17440
    ds_read_u16 v46, v4 offset:17576
    ds_read_u16 v45, v4 offset:17712
    ds_read_u16 v47, v4 offset:17848
    ds_read_u16 v48, v4 offset:17472
    ds_read_u16 v50, v4 offset:17608
    ds_read_u16 v49, v4 offset:17744
    ds_read_u16 v51, v4 offset:17880
    ds_read_u16 v52, v4 offset:17504
    ds_read_u16 v54, v4 offset:17640
    ds_read_u16 v53, v4 offset:17776
    ds_read_u16 v55, v4 offset:17912
    s_waitcnt lgkmcnt(12)
    v_lshl_or_b32 v40, v42, 16, v40
    v_lshl_or_b32 v41, v43, 16, v41
    buffer_store_dwordx2 v[40:41], v200, s[96:99], 0 offen offset:256 sc1
    s_waitcnt lgkmcnt(8)
    v_lshl_or_b32 v44, v46, 16, v44
    v_lshl_or_b32 v45, v47, 16, v45
    buffer_store_dwordx2 v[44:45], v201, s[96:99], 0 offen offset:256 sc1
    s_waitcnt lgkmcnt(4)
    v_lshl_or_b32 v48, v50, 16, v48
    v_lshl_or_b32 v49, v51, 16, v49
    buffer_store_dwordx2 v[48:49], v202, s[96:99], 0 offen offset:256 sc1
    s_waitcnt lgkmcnt(0)
    v_lshl_or_b32 v52, v54, 16, v52
    v_lshl_or_b32 v53, v55, 16, v53
    buffer_store_dwordx2 v[52:53], v203, s[96:99], 0 offen offset:256 sc1
    ds_read_u16 v56, v4 offset:26112
    ds_read_u16 v58, v4 offset:26248
    ds_read_u16 v57, v4 offset:26384
    ds_read_u16 v59, v4 offset:26520
    ds_read_u16 v60, v4 offset:26144
    ds_read_u16 v62, v4 offset:26280
    ds_read_u16 v61, v4 offset:26416
    ds_read_u16 v63, v4 offset:26552
    ds_read_u16 v64, v4 offset:26176
    ds_read_u16 v66, v4 offset:26312
    ds_read_u16 v65, v4 offset:26448
    ds_read_u16 v67, v4 offset:26584
    ds_read_u16 v68, v4 offset:26208
    ds_read_u16 v70, v4 offset:26344
    ds_read_u16 v69, v4 offset:26480
    ds_read_u16 v71, v4 offset:26616
    s_waitcnt lgkmcnt(12)
    v_lshl_or_b32 v56, v58, 16, v56
    v_lshl_or_b32 v57, v59, 16, v57
    buffer_store_dwordx2 v[56:57], v200, s[96:99], 0 offen offset:384 sc1
    s_waitcnt lgkmcnt(8)
    v_lshl_or_b32 v60, v62, 16, v60
    v_lshl_or_b32 v61, v63, 16, v61
    buffer_store_dwordx2 v[60:61], v201, s[96:99], 0 offen offset:384 sc1
    s_waitcnt lgkmcnt(4)
    v_lshl_or_b32 v64, v66, 16, v64
    v_lshl_or_b32 v65, v67, 16, v65
    buffer_store_dwordx2 v[64:65], v202, s[96:99], 0 offen offset:384 sc1
    s_waitcnt lgkmcnt(0)
    v_lshl_or_b32 v68, v70, 16, v68
    v_lshl_or_b32 v69, v71, 16, v69
    buffer_store_dwordx2 v[68:69], v203, s[96:99], 0 offen offset:384 sc1
    ds_read_u16 v72, v4 offset:34816
    ds_read_u16 v74, v4 offset:34952
    ds_read_u16 v73, v4 offset:35088
    ds_read_u16 v75, v4 offset:35224
    ds_read_u16 v76, v4 offset:34848
    ds_read_u16 v78, v4 offset:34984
    ds_read_u16 v77, v4 offset:35120
    ds_read_u16 v79, v4 offset:35256
    ds_read_u16 v80, v4 offset:34880
    ds_read_u16 v82, v4 offset:35016
    ds_read_u16 v81, v4 offset:35152
    ds_read_u16 v83, v4 offset:35288
    ds_read_u16 v84, v4 offset:34912
    ds_read_u16 v86, v4 offset:35048
    ds_read_u16 v85, v4 offset:35184
    ds_read_u16 v87, v4 offset:35320
    s_waitcnt lgkmcnt(12)
    v_lshl_or_b32 v72, v74, 16, v72
    v_lshl_or_b32 v73, v75, 16, v73
    buffer_store_dwordx2 v[72:73], v200, s[96:99], 0 offen offset:512 sc1
    s_waitcnt lgkmcnt(8)
    v_lshl_or_b32 v76, v78, 16, v76
    v_lshl_or_b32 v77, v79, 16, v77
    buffer_store_dwordx2 v[76:77], v201, s[96:99], 0 offen offset:512 sc1
    s_waitcnt lgkmcnt(4)
    v_lshl_or_b32 v80, v82, 16, v80
    v_lshl_or_b32 v81, v83, 16, v81
    buffer_store_dwordx2 v[80:81], v202, s[96:99], 0 offen offset:512 sc1
    s_waitcnt lgkmcnt(0)
    v_lshl_or_b32 v84, v86, 16, v84
    v_lshl_or_b32 v85, v87, 16, v85
    buffer_store_dwordx2 v[84:85], v203, s[96:99], 0 offen offset:512 sc1
    ds_read_u16 v88, v5 offset:0
    ds_read_u16 v90, v5 offset:136
    ds_read_u16 v89, v5 offset:272
    ds_read_u16 v91, v5 offset:408
    ds_read_u16 v92, v5 offset:32
    ds_read_u16 v94, v5 offset:168
    ds_read_u16 v93, v5 offset:304
    ds_read_u16 v95, v5 offset:440
    ds_read_u16 v96, v5 offset:64
    ds_read_u16 v98, v5 offset:200
    ds_read_u16 v97, v5 offset:336
    ds_read_u16 v99, v5 offset:472
    ds_read_u16 v100, v5 offset:96
    ds_read_u16 v102, v5 offset:232
    ds_read_u16 v101, v5 offset:368
    ds_read_u16 v103, v5 offset:504
    s_waitcnt lgkmcnt(12)
    v_lshl_or_b32 v88, v90, 16, v88
    v_lshl_or_b32 v89, v91, 16, v89
    buffer_store_dwordx2 v[88:89], v200, s[96:99], 0 offen offset:640 sc1
    s_waitcnt lgkmcnt(8)
    v_lshl_or_b32 v92, v94, 16, v92
    v_lshl_or_b32 v93, v95, 16, v93
    buffer_store_dwordx2 v[92:93], v201, s[96:99], 0 offen offset:640 sc1
    s_waitcnt lgkmcnt(4)
    v_lshl_or_b32 v96, v98, 16, v96
    v_lshl_or_b32 v97, v99, 16, v97
    buffer_store_dwordx2 v[96:97], v202, s[96:99], 0 offen offset:640 sc1
    s_waitcnt lgkmcnt(0)
    v_lshl_or_b32 v100, v102, 16, v100
    v_lshl_or_b32 v101, v103, 16, v101
    buffer_store_dwordx2 v[100:101], v203, s[96:99], 0 offen offset:640 sc1
    ds_read_u16 v104, v5 offset:8704
    ds_read_u16 v106, v5 offset:8840
    ds_read_u16 v105, v5 offset:8976
    ds_read_u16 v107, v5 offset:9112
    ds_read_u16 v108, v5 offset:8736
    ds_read_u16 v110, v5 offset:8872
    ds_read_u16 v109, v5 offset:9008
    ds_read_u16 v111, v5 offset:9144
    ds_read_u16 v112, v5 offset:8768
    ds_read_u16 v114, v5 offset:8904
    ds_read_u16 v113, v5 offset:9040
    ds_read_u16 v115, v5 offset:9176
    ds_read_u16 v116, v5 offset:8800
    ds_read_u16 v118, v5 offset:8936
    ds_read_u16 v117, v5 offset:9072
    ds_read_u16 v119, v5 offset:9208
    s_waitcnt lgkmcnt(12)
    v_lshl_or_b32 v104, v106, 16, v104
    v_lshl_or_b32 v105, v107, 16, v105
    buffer_store_dwordx2 v[104:105], v200, s[96:99], 0 offen offset:768 sc1
    s_waitcnt lgkmcnt(8)
    v_lshl_or_b32 v108, v110, 16, v108
    v_lshl_or_b32 v109, v111, 16, v109
    buffer_store_dwordx2 v[108:109], v201, s[96:99], 0 offen offset:768 sc1
    s_waitcnt lgkmcnt(4)
    v_lshl_or_b32 v112, v114, 16, v112
    v_lshl_or_b32 v113, v115, 16, v113
    buffer_store_dwordx2 v[112:113], v202, s[96:99], 0 offen offset:768 sc1
    s_waitcnt lgkmcnt(0)
    v_lshl_or_b32 v116, v118, 16, v116
    v_lshl_or_b32 v117, v119, 16, v117
    buffer_store_dwordx2 v[116:117], v203, s[96:99], 0 offen offset:768 sc1
    ds_read_u16 v120, v5 offset:17408
    ds_read_u16 v122, v5 offset:17544
    ds_read_u16 v121, v5 offset:17680
    ds_read_u16 v123, v5 offset:17816
    ds_read_u16 v124, v5 offset:17440
    ds_read_u16 v126, v5 offset:17576
    ds_read_u16 v125, v5 offset:17712
    ds_read_u16 v127, v5 offset:17848
    ds_read_u16 v128, v5 offset:17472
    ds_read_u16 v130, v5 offset:17608
    ds_read_u16 v129, v5 offset:17744
    ds_read_u16 v131, v5 offset:17880
    ds_read_u16 v132, v5 offset:17504
    ds_read_u16 v134, v5 offset:17640
    ds_read_u16 v133, v5 offset:17776
    ds_read_u16 v135, v5 offset:17912
    s_waitcnt lgkmcnt(12)
    v_lshl_or_b32 v120, v122, 16, v120
    v_lshl_or_b32 v121, v123, 16, v121
    buffer_store_dwordx2 v[120:121], v200, s[96:99], 0 offen offset:896 sc1
    s_waitcnt lgkmcnt(8)
    v_lshl_or_b32 v124, v126, 16, v124
    v_lshl_or_b32 v125, v127, 16, v125
    buffer_store_dwordx2 v[124:125], v201, s[96:99], 0 offen offset:896 sc1
    s_waitcnt lgkmcnt(4)
    v_lshl_or_b32 v128, v130, 16, v128
    v_lshl_or_b32 v129, v131, 16, v129
    buffer_store_dwordx2 v[128:129], v202, s[96:99], 0 offen offset:896 sc1
    s_waitcnt lgkmcnt(0)
    v_lshl_or_b32 v132, v134, 16, v132
    v_lshl_or_b32 v133, v135, 16, v133
    buffer_store_dwordx2 v[132:133], v203, s[96:99], 0 offen offset:896 sc1
    ds_read_u16 v136, v5 offset:26112
    ds_read_u16 v138, v5 offset:26248
    ds_read_u16 v137, v5 offset:26384
    ds_read_u16 v139, v5 offset:26520
    ds_read_u16 v140, v5 offset:26144
    ds_read_u16 v142, v5 offset:26280
    ds_read_u16 v141, v5 offset:26416
    ds_read_u16 v143, v5 offset:26552
    ds_read_u16 v144, v5 offset:26176
    ds_read_u16 v146, v5 offset:26312
    ds_read_u16 v145, v5 offset:26448
    ds_read_u16 v147, v5 offset:26584
    ds_read_u16 v148, v5 offset:26208
    ds_read_u16 v150, v5 offset:26344
    ds_read_u16 v149, v5 offset:26480
    ds_read_u16 v151, v5 offset:26616
    s_waitcnt lgkmcnt(12)
    v_lshl_or_b32 v136, v138, 16, v136
    v_lshl_or_b32 v137, v139, 16, v137
    buffer_store_dwordx2 v[136:137], v200, s[96:99], 0 offen offset:1024 sc1
    s_waitcnt lgkmcnt(8)
    v_lshl_or_b32 v140, v142, 16, v140
    v_lshl_or_b32 v141, v143, 16, v141
    buffer_store_dwordx2 v[140:141], v201, s[96:99], 0 offen offset:1024 sc1
    s_waitcnt lgkmcnt(4)
    v_lshl_or_b32 v144, v146, 16, v144
    v_lshl_or_b32 v145, v147, 16, v145
    buffer_store_dwordx2 v[144:145], v202, s[96:99], 0 offen offset:1024 sc1
    s_waitcnt lgkmcnt(0)
    v_lshl_or_b32 v148, v150, 16, v148
    v_lshl_or_b32 v149, v151, 16, v149
    buffer_store_dwordx2 v[148:149], v203, s[96:99], 0 offen offset:1024 sc1
    ds_read_u16 v152, v5 offset:34816
    ds_read_u16 v154, v5 offset:34952
    ds_read_u16 v153, v5 offset:35088
    ds_read_u16 v155, v5 offset:35224
    ds_read_u16 v156, v5 offset:34848
    ds_read_u16 v158, v5 offset:34984
    ds_read_u16 v157, v5 offset:35120
    ds_read_u16 v159, v5 offset:35256
    ds_read_u16 v160, v5 offset:34880
    ds_read_u16 v162, v5 offset:35016
    ds_read_u16 v161, v5 offset:35152
    ds_read_u16 v163, v5 offset:35288
    ds_read_u16 v164, v5 offset:34912
    ds_read_u16 v166, v5 offset:35048
    ds_read_u16 v165, v5 offset:35184
    ds_read_u16 v167, v5 offset:35320
    s_waitcnt lgkmcnt(12)
    v_lshl_or_b32 v152, v154, 16, v152
    v_lshl_or_b32 v153, v155, 16, v153
    buffer_store_dwordx2 v[152:153], v200, s[96:99], 0 offen offset:1152 sc1
    s_waitcnt lgkmcnt(8)
    v_lshl_or_b32 v156, v158, 16, v156
    v_lshl_or_b32 v157, v159, 16, v157
    buffer_store_dwordx2 v[156:157], v201, s[96:99], 0 offen offset:1152 sc1
    s_waitcnt lgkmcnt(4)
    v_lshl_or_b32 v160, v162, 16, v160
    v_lshl_or_b32 v161, v163, 16, v161
    buffer_store_dwordx2 v[160:161], v202, s[96:99], 0 offen offset:1152 sc1
    s_waitcnt lgkmcnt(0)
    v_lshl_or_b32 v164, v166, 16, v164
    v_lshl_or_b32 v165, v167, 16, v165
    buffer_store_dwordx2 v[164:165], v203, s[96:99], 0 offen offset:1152 sc1
    s_waitcnt vmcnt(0)
    s_barrier
    s_cmp_lg_u32 s7, 0
    s_cbranch_scc1 sg2_d
    v_mov_b32 v250, 1
    s_mov_b64 exec, 1
    buffer_atomic_add v250, off, s[96:99], s36 sc1
sg2_d:
    s_branch wk_end
wk_ab:
    s_sub_u32 s2, s2, 240
    s_cmp_ge_u32 s2, 256
    s_cbranch_scc1 wk_gb
    v_mov_b32 v250, 152576000
    v_mov_b32 v251, 240
    s_mov_b32 s36, 152576256
    s_branch att_b
wk_gb:
    s_sub_u32 s2, s2, 256
    s_cmp_ge_u32 s2, 80
    s_cbranch_scc1 wk_a
    s_and_b32 s4, s2, 15
    s_lshr_b32 s5, s2, 4
    v_mov_b32 v250, 152576256
    v_mov_b32 v251, 256
    s_branch g2_p1
wk_a:
    s_sub_u32 s2, s2, 80
    s_cmp_ge_u32 s2, 481
    s_cbranch_scc1 wk_f
    s_mul_i32 s4, s2, 1772
    s_lshr_b32 s4, s4, 16
    s_mul_i32 s5, s4, 37
    s_sub_u32 s5, s2, s5
    s_cmp_ge_u32 s5, 32
    s_cbranch_scc1 wk_ga
    s_lshl_b32 s2, s4, 5
    s_add_u32 s2, s2, s5
wk_a2:
    s_lshr_b32 s4, s2, 5
    s_lshr_b32 s3, s2, 3
    s_lshl_b32 s36, s3, 8
    s_add_u32 s36, s36, 152584192
    s_add_u32 s3, s3, 1
    s_and_b32 s5, s2, 7
    s_lshl_b32 s5, s5, 8
    s_add_u32 s5, s5, 152600576
    v_min_u32 v253, 7, v2
    v_lshlrev_b32 v253, 2, v253
    v_add_u32 v253, s5, v253
    v_mov_b32 v254, s3
    s_lshl_b32 s5, s4, 8
    s_add_u32 s6, s5, 152567808
    s_add_u32 s5, s5, 152571904
    v_cmp_eq_u32 vcc, 0, v2
    v_mov_b32 v1, s6
    v_mov_b32 v3, 64
    v_mov_b32 v250, s5
    v_mov_b32 v251, 32
    v_cndmask_b32 v250, v250, v1, vcc
    v_cndmask_b32 v251, v251, v3, vcc
    s_branch att_a
wk_ga:
    s_sub_u32 s5, s5, 32
    s_lshl_b32 s3, s4, 10
    s_add_u32 s3, s3, 152584192
    v_min_u32 v250, 3, v2
    v_lshlrev_b32 v250, 8, v250
    v_add_u32 v250, s3, v250
    v_mov_b32 v251, 8
    s_branch g2_p0
wk_f:
    s_sub_u32 s2, s2, 481
    s_cmp_ge_u32 s2, 8
    s_cbranch_scc1 wk_f0
    s_add_u32 s2, s2, 416
    s_branch wk_a2
wk_f0:
    s_sub_u32 s2, s2, 8
    s_cmp_ge_u32 s2, 252
    s_cbranch_scc1 wk_f1
    s_mul_i32 s4, s2, 2341
    s_lshr_b32 s4, s4, 16
    s_mul_i32 s5, s4, 28
    s_sub_u32 s5, s2, s5
    s_add_u32 s4, s4, 52
    s_cmp_ge_u32 s5, 8
    s_cbranch_scc1 fine2
    s_cmp_ge_u32 s4, 63
    s_cbranch_scc1 wk_end
    s_lshl_b32 s2, s4, 3
    s_add_u32 s2, s2, s5
    s_add_u32 s2, s2, 8
    s_branch wk_a2
wk_f1:
    s_sub_u32 s2, s2, 252
    s_mul_i32 s4, s2, 1366
    s_lshr_b32 s4, s4, 16
    s_mul_i32 s5, s4, 48
    s_sub_u32 s5, s2, s5
    s_add_u32 s4, s4, 61
    s_cmp_ge_u32 s5, 8
    s_cbranch_scc1 fine1
    s_cmp_ge_u32 s4, 63
    s_cbranch_scc1 wk_end
    s_lshl_b32 s2, s4, 3
    s_add_u32 s2, s2, s5
    s_add_u32 s2, s2, 8
    s_branch wk_a2
wk_end:
    s_endpgm
g1_p0:
    s_load_dwordx2 s[8:9], s[0:1], 0
    s_waitcnt lgkmcnt(0)
    s_mov_b32 s10, 2621440
    s_mov_b32 s11, 0x00020000
    s_load_dwordx2 s[12:13], s[0:1], 96
    s_waitcnt lgkmcnt(0)
    s_mov_b32 s14, 268435456
    s_mov_b32 s15, 0x00020000
    s_mul_i32 s16, s4, 163840
    s_add_u32 s16, s16, 0
    s_mul_i32 s17, s5, 163840
    s_add_u32 s17, s17, 0
    s_mul_i32 s18, s4, 2097152
    s_lshl_b32 s19, s5, 8
    s_add_u32 s18, s18, s19
    s_add_u32 s18, s18, 33554432
    s_mov_b32 s22, 16384
    s_mov_b32 s27, 128
    s_mov_b32 s28, 64
    s_mov_b32 s26, 16384
    s_mov_b32 s20, 1280
    s_mov_b32 s21, 1280
    s_mov_b32 s23, 4
    s_branch g1_go
g1_p1:
    s_load_dwordx2 s[8:9], s[0:1], 0
    s_waitcnt lgkmcnt(0)
    s_mov_b32 s10, 2621440
    s_mov_b32 s11, 0x00020000
    s_load_dwordx2 s[12:13], s[0:1], 96
    s_waitcnt lgkmcnt(0)
    s_mov_b32 s14, 268435456
    s_mov_b32 s15, 0x00020000
    s_mul_i32 s16, s4, 163840
    s_add_u32 s16, s16, 0
    s_mul_i32 s17, s5, 163840
    s_add_u32 s17, s17, 10485760
    s_lshl_b32 s18, s4, 20
    s_lshl_b32 s19, s5, 13
    s_add_u32 s18, s18, s19
    s_add_u32 s18, s18, 67108864
    s_mov_b32 s22, 64
    s_mov_b32 s27, 524288
    s_mov_b32 s28, 262144
    s_mov_b32 s26, 0
    s_mov_b32 s20, 1280
    s_mov_b32 s21, 1280
    s_mov_b32 s23, 4
    s_branch g1_go
g1_p2:
    s_load_dwordx2 s[8:9], s[0:1], 56
    s_waitcnt lgkmcnt(0)
    s_mov_b32 s10, 2621440
    s_mov_b32 s11, 0x00020000
    s_load_dwordx2 s[12:13], s[0:1], 96
    s_waitcnt lgkmcnt(0)
    s_mov_b32 s14, 268435456
    s_mov_b32 s15, 0x00020000
    s_mul_i32 s16, s4, 163840
    s_add_u32 s16, s16, 0
    s_mul_i32 s17, s5, 163840
    s_add_u32 s17, s17, 23068672
    s_mul_i32 s18, s4, 491520
    s_lshl_b32 s19, s5, 8
    s_add_u32 s18, s18, s19
    s_add_u32 s18, s18, 100663296
    s_mov_b32 s22, 3840
    s_mov_b32 s27, 128
    s_mov_b32 s28, 64
    s_mov_b32 s26, 16384
    s_mov_b32 s20, 1280
    s_mov_b32 s21, 1280
    s_mov_b32 s23, 4
    s_branch g1_go
g1_go:
    v_lshrrev_b32 v1, 6, v0
    v_and_b32 v2, 63, v0
    s_nop 0
    v_readfirstlane_b32 s7, v1
    v_lshrrev_b32 v3, 3, v2
    v_and_b32 v4, 7, v2
    v_lshrrev_b32 v5, 4, v2
    v_xor_b32 v5, v4, v5
    v_lshlrev_b32 v5, 4, v5
    v_xor_b32 v6, 64, v5
    v_lshl_add_u32 v7, v1, 5, v3
    v_add_u32 v8, 8, v7
    v_mul_lo_u32 v10, v7, s20
    v_add_u32 v10, v10, v5
    v_mul_lo_u32 v11, v8, s20
    v_add_u32 v11, v11, v6
    v_mul_lo_u32 v12, v7, s21
    v_add_u32 v12, v12, v5
    v_mul_lo_u32 v13, v8, s21
    v_add_u32 v13, v13, v6
    s_lshl_b32 s19, s20, 4
    s_add_u32 s30, s16, s19
    s_lshl_b32 s19, s21, 4
    s_add_u32 s31, s17, s19
    s_lshl_b32 s29, s7, 12
    s_add_u32 m0, s29, 0
    s_nop 0
    buffer_load_dwordx4 v10, s[8:11], s16 offen lds
    s_add_u32 m0, s29, 1024
    s_nop 0
    buffer_load_dwordx4 v11, s[8:11], s16 offen lds
    s_add_u32 m0, s29, 2048
    s_nop 0
    buffer_load_dwordx4 v10, s[8:11], s30 offen lds
    s_add_u32 m0, s29, 3072
    s_nop 0
    buffer_load_dwordx4 v11, s[8:11], s30 offen lds
    s_add_u32 m0, s29, 16384
    s_nop 0
    buffer_load_dwordx4 v12, s[96:99], s17 offen lds
    s_add_u32 m0, s29, 17408
    s_nop 0
    buffer_load_dwordx4 v13, s[96:99], s17 offen lds
    s_add_u32 m0, s29, 18432
    s_nop 0
    buffer_load_dwordx4 v12, s[96:99], s31 offen lds
    s_add_u32 m0, s29, 19456
    s_nop 0
    buffer_load_dwordx4 v13, s[96:99], s31 offen lds
    s_add_u32 s16, s16, 128
    s_add_u32 s17, s17, 128
    s_add_u32 s30, s30, 128
    s_add_u32 s31, s31, 128
    v_and_b32 v3, 31, v2
    v_lshrrev_b32 v4, 5, v2
    v_bfe_u32 v5, v2, 1, 3
    s_and_b32 s4, s7, 1
    s_lshr_b32 s5, s7, 1
    s_lshl_b32 s24, s4, 13
    s_add_u32 s24, s24, s26
    s_lshl_b32 s25, s5, 13
    s_sub_u32 s19, 16384, s26
    s_add_u32 s25, s25, s19
    v_or_b32 v6, 0, v4
    v_xor_b32 v6, v6, v5
    v_lshlrev_b32 v6, 4, v6
    v_lshl_add_u32 v6, v3, 7, v6
    v_add_u32 v16, s24, v6
    v_add_u32 v20, s25, v6
    v_or_b32 v6, 2, v4
    v_xor_b32 v6, v6, v5
    v_lshlrev_b32 v6, 4, v6
    v_lshl_add_u32 v6, v3, 7, v6
    v_add_u32 v17, s24, v6
    v_add_u32 v21, s25, v6
    v_or_b32 v6, 4, v4
    v_xor_b32 v6, v6, v5
    v_lshlrev_b32 v6, 4, v6
    v_lshl_add_u32 v6, v3, 7, v6
    v_add_u32 v18, s24, v6
    v_add_u32 v22, s25, v6
    v_or_b32 v6, 6, v4
    v_xor_b32 v6, v6, v5
    v_lshlrev_b32 v6, 4, v6
    v_lshl_add_u32 v6, v3, 7, v6
    v_add_u32 v19, s24, v6
    v_add_u32 v23, s25, v6
    v_mov_b32 v64, 0
    v_mov_b32 v65, 0
    v_mov_b32 v66, 0
    v_mov_b32 v67, 0
    v_mov_b32 v68, 0
    v_mov_b32 v69, 0
    v_mov_b32 v70, 0
    v_mov_b32 v71, 0
    v_mov_b32 v72, 0
    v_mov_b32 v73, 0
    v_mov_b32 v74, 0
    v_mov_b32 v75, 0
    v_mov_b32 v76, 0
    v_mov_b32 v77, 0
    v_mov_b32 v78, 0
    v_mov_b32 v79, 0
    v_mov_b32 v80, 0
    v_mov_b32 v81, 0
    v_mov_b32 v82, 0
    v_mov_b32 v83, 0
    v_mov_b32 v84, 0
    v_mov_b32 v85, 0
    v_mov_b32 v86, 0
    v_mov_b32 v87, 0
    v_mov_b32 v88, 0
    v_mov_b32 v89, 0
    v_mov_b32 v90, 0
    v_mov_b32 v91, 0
    v_mov_b32 v92, 0
    v_mov_b32 v93, 0
    v_mov_b32 v94, 0
    v_mov_b32 v95, 0
    v_mov_b32 v96, 0
    v_mov_b32 v97, 0
    v_mov_b32 v98, 0
    v_mov_b32 v99, 0
    v_mov_b32 v100, 0
    v_mov_b32 v101, 0
    v_mov_b32 v102, 0
    v_mov_b32 v103, 0
    v_mov_b32 v104, 0
    v_mov_b32 v105, 0
    v_mov_b32 v106, 0
    v_mov_b32 v107, 0
    v_mov_b32 v108, 0
    v_mov_b32 v109, 0
    v_mov_b32 v110, 0
    v_mov_b32 v111, 0
    v_mov_b32 v112, 0
    v_mov_b32 v113, 0
    v_mov_b32 v114, 0
    v_mov_b32 v115, 0
    v_mov_b32 v116, 0
    v_mov_b32 v117, 0
    v_mov_b32 v118, 0
    v_mov_b32 v119, 0
    v_mov_b32 v120, 0
    v_mov_b32 v121, 0
    v_mov_b32 v122, 0
    v_mov_b32 v123, 0
    v_mov_b32 v124, 0
    v_mov_b32 v125, 0
    v_mov_b32 v126, 0
    v_mov_b32 v127, 0
    s_cmp_eq_u32 s23, 0
    s_cbranch_scc1 g1_tail
g1_loop:
    s_waitcnt vmcnt(0)
    s_barrier
    ds_read_b128 v[32:35], v16 offset:0
    ds_read_b128 v[36:39], v16 offset:4096
    ds_read_b128 v[40:43], v20 offset:0
    ds_read_b128 v[44:47], v20 offset:4096
    ds_read_b128 v[48:51], v17 offset:0
    ds_read_b128 v[52:55], v17 offset:4096
    ds_read_b128 v[56:59], v21 offset:0
    ds_read_b128 v[60:63], v21 offset:4096
    s_add_u32 m0, s29, 32768
    s_nop 0
    buffer_load_dwordx4 v10, s[8:11], s16 offen lds
    s_add_u32 m0, s29, 33792
    s_nop 0
    buffer_load_dwordx4 v11, s[8:11], s16 offen lds
    s_waitcnt lgkmcnt(4)
    v_mfma_f32_32x32x16_bf16 v[64:79], v[32:35], v[40:43], v[64:79]
    s_add_u32 m0, s29, 34816
    s_nop 0
    buffer_load_dwordx4 v10, s[8:11], s30 offen lds
    v_mfma_f32_32x32x16_bf16 v[80:95], v[32:35], v[44:47], v[80:95]
    s_add_u32 m0, s29, 35840
    s_nop 0
    buffer_load_dwordx4 v11, s[8:11], s30 offen lds
    v_mfma_f32_32x32x16_bf16 v[96:111], v[36:39], v[40:43], v[96:111]
    s_add_u32 m0, s29, 49152
    s_nop 0
    buffer_load_dwordx4 v12, s[96:99], s17 offen lds
    v_mfma_f32_32x32x16_bf16 v[112:127], v[36:39], v[44:47], v[112:127]
    s_add_u32 m0, s29, 50176
    s_nop 0
    buffer_load_dwordx4 v13, s[96:99], s17 offen lds
    ds_read_b128 v[32:35], v18 offset:0
    ds_read_b128 v[36:39], v18 offset:4096
    ds_read_b128 v[40:43], v22 offset:0
    ds_read_b128 v[44:47], v22 offset:4096
    s_waitcnt lgkmcnt(4)
    v_mfma_f32_32x32x16_bf16 v[64:79], v[48:51], v[56:59], v[64:79]
    s_add_u32 m0, s29, 51200
    s_nop 0
    buffer_load_dwordx4 v12, s[96:99], s31 offen lds
    v_mfma_f32_32x32x16_bf16 v[80:95], v[48:51], v[60:63], v[80:95]
    s_add_u32 m0, s29, 52224
    s_nop 0
    buffer_load_dwordx4 v13, s[96:99], s31 offen lds
    v_mfma_f32_32x32x16_bf16 v[96:111], v[52:55], v[56:59], v[96:111]
    v_mfma_f32_32x32x16_bf16 v[112:127], v[52:55], v[60:63], v[112:127]
    ds_read_b128 v[48:51], v19 offset:0
    ds_read_b128 v[52:55], v19 offset:4096
    ds_read_b128 v[56:59], v23 offset:0
    ds_read_b128 v[60:63], v23 offset:4096
    s_waitcnt lgkmcnt(4)
    v_mfma_f32_32x32x16_bf16 v[64:79], v[32:35], v[40:43], v[64:79]
    v_mfma_f32_32x32x16_bf16 v[80:95], v[32:35], v[44:47], v[80:95]
    v_mfma_f32_32x32x16_bf16 v[96:111], v[36:39], v[40:43], v[96:111]
    v_mfma_f32_32x32x16_bf16 v[112:127], v[36:39], v[44:47], v[112:127]
    s_waitcnt lgkmcnt(0)
    v_mfma_f32_32x32x16_bf16 v[64:79], v[48:51], v[56:59], v[64:79]
    v_mfma_f32_32x32x16_bf16 v[80:95], v[48:51], v[60:63], v[80:95]
    v_mfma_f32_32x32x16_bf16 v[96:111], v[52:55], v[56:59], v[96:111]
    v_mfma_f32_32x32x16_bf16 v[112:127], v[52:55], v[60:63], v[112:127]
    s_add_u32 s16, s16, 128
    s_add_u32 s17, s17, 128
    s_add_u32 s30, s30, 128
    s_add_u32 s31, s31, 128
    s_waitcnt vmcnt(0)
    s_barrier
    ds_read_b128 v[32:35], v16 offset:32768
    ds_read_b128 v[36:39], v16 offset:36864
    ds_read_b128 v[40:43], v20 offset:32768
    ds_read_b128 v[44:47], v20 offset:36864
    ds_read_b128 v[48:51], v17 offset:32768
    ds_read_b128 v[52:55], v17 offset:36864
    ds_read_b128 v[56:59], v21 offset:32768
    ds_read_b128 v[60:63], v21 offset:36864
    s_add_u32 m0, s29, 0
    s_nop 0
    buffer_load_dwordx4 v10, s[8:11], s16 offen lds
    s_add_u32 m0, s29, 1024
    s_nop 0
    buffer_load_dwordx4 v11, s[8:11], s16 offen lds
    s_waitcnt lgkmcnt(4)
    v_mfma_f32_32x32x16_bf16 v[64:79], v[32:35], v[40:43], v[64:79]
    s_add_u32 m0, s29, 2048
    s_nop 0
    buffer_load_dwordx4 v10, s[8:11], s30 offen lds
    v_mfma_f32_32x32x16_bf16 v[80:95], v[32:35], v[44:47], v[80:95]
    s_add_u32 m0, s29, 3072
    s_nop 0
    buffer_load_dwordx4 v11, s[8:11], s30 offen lds
    v_mfma_f32_32x32x16_bf16 v[96:111], v[36:39], v[40:43], v[96:111]
    s_add_u32 m0, s29, 16384
    s_nop 0
    buffer_load_dwordx4 v12, s[96:99], s17 offen lds
    v_mfma_f32_32x32x16_bf16 v[112:127], v[36:39], v[44:47], v[112:127]
    s_add_u32 m0, s29, 17408
    s_nop 0
    buffer_load_dwordx4 v13, s[96:99], s17 offen lds
    ds_read_b128 v[32:35], v18 offset:32768
    ds_read_b128 v[36:39], v18 offset:36864
    ds_read_b128 v[40:43], v22 offset:32768
    ds_read_b128 v[44:47], v22 offset:36864
    s_waitcnt lgkmcnt(4)
    v_mfma_f32_32x32x16_bf16 v[64:79], v[48:51], v[56:59], v[64:79]
    s_add_u32 m0, s29, 18432
    s_nop 0
    buffer_load_dwordx4 v12, s[96:99], s31 offen lds
    v_mfma_f32_32x32x16_bf16 v[80:95], v[48:51], v[60:63], v[80:95]
    s_add_u32 m0, s29, 19456
    s_nop 0
    buffer_load_dwordx4 v13, s[96:99], s31 offen lds
    v_mfma_f32_32x32x16_bf16 v[96:111], v[52:55], v[56:59], v[96:111]
    v_mfma_f32_32x32x16_bf16 v[112:127], v[52:55], v[60:63], v[112:127]
    ds_read_b128 v[48:51], v19 offset:32768
    ds_read_b128 v[52:55], v19 offset:36864
    ds_read_b128 v[56:59], v23 offset:32768
    ds_read_b128 v[60:63], v23 offset:36864
    s_waitcnt lgkmcnt(4)
    v_mfma_f32_32x32x16_bf16 v[64:79], v[32:35], v[40:43], v[64:79]
    v_mfma_f32_32x32x16_bf16 v[80:95], v[32:35], v[44:47], v[80:95]
    v_mfma_f32_32x32x16_bf16 v[96:111], v[36:39], v[40:43], v[96:111]
    v_mfma_f32_32x32x16_bf16 v[112:127], v[36:39], v[44:47], v[112:127]
    s_waitcnt lgkmcnt(0)
    v_mfma_f32_32x32x16_bf16 v[64:79], v[48:51], v[56:59], v[64:79]
    v_mfma_f32_32x32x16_bf16 v[80:95], v[48:51], v[60:63], v[80:95]
    v_mfma_f32_32x32x16_bf16 v[96:111], v[52:55], v[56:59], v[96:111]
    v_mfma_f32_32x32x16_bf16 v[112:127], v[52:55], v[60:63], v[112:127]
    s_add_u32 s16, s16, 128
    s_add_u32 s17, s17, 128
    s_add_u32 s30, s30, 128
    s_add_u32 s31, s31, 128
    s_sub_u32 s23, s23, 1
    s_cmp_lg_u32 s23, 0
    s_cbranch_scc1 g1_loop
g1_tail:
    s_waitcnt vmcnt(0)
    s_barrier
    ds_read_b128 v[32:35], v16 offset:0
    ds_read_b128 v[36:39], v16 offset:4096
    ds_read_b128 v[40:43], v20 offset:0
    ds_read_b128 v[44:47], v20 offset:4096
    ds_read_b128 v[48:51], v17 offset:0
    ds_read_b128 v[52:55], v17 offset:4096
    ds_read_b128 v[56:59], v21 offset:0
    ds_read_b128 v[60:63], v21 offset:4096
    s_add_u32 m0, s29, 32768
    s_nop 0
    buffer_load_dwordx4 v10, s[8:11], s16 offen lds
    s_add_u32 m0, s29, 33792
    s_nop 0
    buffer_load_dwordx4 v11, s[8:11], s16 offen lds
    s_waitcnt lgkmcnt(4)
    v_mfma_f32_32x32x16_bf16 v[64:79], v[32:35], v[40:43], v[64:79]
    s_add_u32 m0, s29, 34816
    s_nop 0
    buffer_load_dwordx4 v10, s[8:11], s30 offen lds
    v_mfma_f32_32x32x16_bf16 v[80:95], v[32:35], v[44:47], v[80:95]
    s_add_u32 m0, s29, 35840
    s_nop 0
    buffer_load_dwordx4 v11, s[8:11], s30 offen lds
    v_mfma_f32_32x32x16_bf16 v[96:111], v[36:39], v[40:43], v[96:111]
    s_add_u32 m0, s29, 49152
    s_nop 0
    buffer_load_dwordx4 v12, s[96:99], s17 offen lds
    v_mfma_f32_32x32x16_bf16 v[112:127], v[36:39], v[44:47], v[112:127]
    s_add_u32 m0, s29, 50176
    s_nop 0
    buffer_load_dwordx4 v13, s[96:99], s17 offen lds
    ds_read_b128 v[32:35], v18 offset:0
    ds_read_b128 v[36:39], v18 offset:4096
    ds_read_b128 v[40:43], v22 offset:0
    ds_read_b128 v[44:47], v22 offset:4096
    s_waitcnt lgkmcnt(4)
    v_mfma_f32_32x32x16_bf16 v[64:79], v[48:51], v[56:59], v[64:79]
    s_add_u32 m0, s29, 51200
    s_nop 0
    buffer_load_dwordx4 v12, s[96:99], s31 offen lds
    v_mfma_f32_32x32x16_bf16 v[80:95], v[48:51], v[60:63], v[80:95]
    s_add_u32 m0, s29, 52224
    s_nop 0
    buffer_load_dwordx4 v13, s[96:99], s31 offen lds
    v_mfma_f32_32x32x16_bf16 v[96:111], v[52:55], v[56:59], v[96:111]
    v_mfma_f32_32x32x16_bf16 v[112:127], v[52:55], v[60:63], v[112:127]
    ds_read_b128 v[48:51], v19 offset:0
    ds_read_b128 v[52:55], v19 offset:4096
    ds_read_b128 v[56:59], v23 offset:0
    ds_read_b128 v[60:63], v23 offset:4096
    s_waitcnt lgkmcnt(4)
    v_mfma_f32_32x32x16_bf16 v[64:79], v[32:35], v[40:43], v[64:79]
    v_mfma_f32_32x32x16_bf16 v[80:95], v[32:35], v[44:47], v[80:95]
    v_mfma_f32_32x32x16_bf16 v[96:111], v[36:39], v[40:43], v[96:111]
    v_mfma_f32_32x32x16_bf16 v[112:127], v[36:39], v[44:47], v[112:127]
    s_waitcnt lgkmcnt(0)
    v_mfma_f32_32x32x16_bf16 v[64:79], v[48:51], v[56:59], v[64:79]
    v_mfma_f32_32x32x16_bf16 v[80:95], v[48:51], v[60:63], v[80:95]
    v_mfma_f32_32x32x16_bf16 v[96:111], v[52:55], v[56:59], v[96:111]
    v_mfma_f32_32x32x16_bf16 v[112:127], v[52:55], v[60:63], v[112:127]
    s_add_u32 s16, s16, 128
    s_add_u32 s17, s17, 128
    s_add_u32 s30, s30, 128
    s_add_u32 s31, s31, 128
    s_waitcnt vmcnt(0)
    s_barrier
    ds_read_b128 v[32:35], v16 offset:32768
    ds_read_b128 v[36:39], v16 offset:36864
    ds_read_b128 v[40:43], v20 offset:32768
    ds_read_b128 v[44:47], v20 offset:36864
    ds_read_b128 v[48:51], v17 offset:32768
    ds_read_b128 v[52:55], v17 offset:36864
    ds_read_b128 v[56:59], v21 offset:32768
    ds_read_b128 v[60:63], v21 offset:36864
    s_waitcnt lgkmcnt(4)
    v_mfma_f32_32x32x16_bf16 v[64:79], v[32:35], v[40:43], v[64:79]
    v_mfma_f32_32x32x16_bf16 v[80:95], v[32:35], v[44:47], v[80:95]
    v_mfma_f32_32x32x16_bf16 v[96:111], v[36:39], v[40:43], v[96:111]
    v_mfma_f32_32x32x16_bf16 v[112:127], v[36:39], v[44:47], v[112:127]
    ds_read_b128 v[32:35], v18 offset:32768
    ds_read_b128 v[36:39], v18 offset:36864
    ds_read_b128 v[40:43], v22 offset:32768
    ds_read_b128 v[44:47], v22 offset:36864
    s_waitcnt lgkmcnt(4)
    v_mfma_f32_32x32x16_bf16 v[64:79], v[48:51], v[56:59], v[64:79]
    v_mfma_f32_32x32x16_bf16 v[80:95], v[48:51], v[60:63], v[80:95]
    v_mfma_f32_32x32x16_bf16 v[96:111], v[52:55], v[56:59], v[96:111]
    v_mfma_f32_32x32x16_bf16 v[112:127], v[52:55], v[60:63], v[112:127]
    ds_read_b128 v[48:51], v19 offset:32768
    ds_read_b128 v[52:55], v19 offset:36864
    ds_read_b128 v[56:59], v23 offset:32768
    ds_read_b128 v[60:63], v23 offset:36864
    s_waitcnt lgkmcnt(4)
    v_mfma_f32_32x32x16_bf16 v[64:79], v[32:35], v[40:43], v[64:79]
    v_mfma_f32_32x32x16_bf16 v[80:95], v[32:35], v[44:47], v[80:95]
    v_mfma_f32_32x32x16_bf16 v[96:111], v[36:39], v[40:43], v[96:111]
    v_mfma_f32_32x32x16_bf16 v[112:127], v[36:39], v[44:47], v[112:127]
    s_waitcnt lgkmcnt(0)
    v_mfma_f32_32x32x16_bf16 v[64:79], v[48:51], v[56:59], v[64:79]
    v_mfma_f32_32x32x16_bf16 v[80:95], v[48:51], v[60:63], v[80:95]
    v_mfma_f32_32x32x16_bf16 v[96:111], v[52:55], v[56:59], v[96:111]
    v_mfma_f32_32x32x16_bf16 v[112:127], v[52:55], v[60:63], v[112:127]
    s_mul_i32 s19, s7, 9216
    v_mul_u32_u24 v6, 144, v3
    v_lshl_add_u32 v6, v4, 3, v6
    v_add_u32 v6, s19, v6
    v_lshrrev_b32 v7, 3, v2
    v_and_b32 v8, 7, v2
    v_mul_u32_u24 v9, 144, v7
    v_lshl_add_u32 v9, v8, 4, v9
    v_add_u32 v9, s19, v9
    s_lshl_b32 s19, s5, 6
    v_add_u32 v7, s19, v7
    v_mul_lo_u32 v7, v7, s22
    v_lshrrev_b32 v10, 2, v8
    v_mul_lo_u32 v10, v10, s28
    v_add_u32 v7, v7, v10
    v_and_b32 v8, 3, v8
    v_lshl_add_u32 v7, v8, 4, v7
    s_mul_i32 s19, s4, s27
    s_add_u32 s18, s18, s19
    s_lshl_b32 s19, s22, 3
    s_barrier
    s_nop 7
    v_cvt_pk_bf16_f32 v64, v64, v65
    v_cvt_pk_bf16_f32 v65, v66, v67
    ds_write_b64 v6, v[64:65] offset:0
    v_cvt_pk_bf16_f32 v68, v68, v69
    v_cvt_pk_bf16_f32 v69, v70, v71
    ds_write_b64 v6, v[68:69] offset:16
    v_cvt_pk_bf16_f32 v72, v72, v73
    v_cvt_pk_bf16_f32 v73, v74, v75
    ds_write_b64 v6, v[72:73] offset:32
    v_cvt_pk_bf16_f32 v76, v76, v77
    v_cvt_pk_bf16_f32 v77, v78, v79
    ds_write_b64 v6, v[76:77] offset:48
    v_cvt_pk_bf16_f32 v80, v80, v81
    v_cvt_pk_bf16_f32 v81, v82, v83
    ds_write_b64 v6, v[80:81] offset:4608
    v_cvt_pk_bf16_f32 v84, v84, v85
    v_cvt_pk_bf16_f32 v85, v86, v87
    ds_write_b64 v6, v[84:85] offset:4624
    v_cvt_pk_bf16_f32 v88, v88, v89
    v_cvt_pk_bf16_f32 v89, v90, v91
    ds_write_b64 v6, v[88:89] offset:4640
    v_cvt_pk_bf16_f32 v92, v92, v93
    v_cvt_pk_bf16_f32 v93, v94, v95
    ds_write_b64 v6, v[92:93] offset:4656
    v_cvt_pk_bf16_f32 v96, v96, v97
    v_cvt_pk_bf16_f32 v97, v98, v99
    ds_write_b64 v6, v[96:97] offset:64
    v_cvt_pk_bf16_f32 v100, v100, v101
    v_cvt_pk_bf16_f32 v101, v102, v103
    ds_write_b64 v6, v[100:101] offset:80
    v_cvt_pk_bf16_f32 v104, v104, v105
    v_cvt_pk_bf16_f32 v105, v106, v107
    ds_write_b64 v6, v[104:105] offset:96
    v_cvt_pk_bf16_f32 v108, v108, v109
    v_cvt_pk_bf16_f32 v109, v110, v111
    ds_write_b64 v6, v[108:109] offset:112
    v_cvt_pk_bf16_f32 v112, v112, v113
    v_cvt_pk_bf16_f32 v113, v114, v115
    ds_write_b64 v6, v[112:113] offset:4672
    v_cvt_pk_bf16_f32 v116, v116, v117
    v_cvt_pk_bf16_f32 v117, v118, v119
    ds_write_b64 v6, v[116:117] offset:4688
    v_cvt_pk_bf16_f32 v120, v120, v121
    v_cvt_pk_bf16_f32 v121, v122, v123
    ds_write_b64 v6, v[120:121] offset:4704
    v_cvt_pk_bf16_f32 v124, v124, v125
    v_cvt_pk_bf16_f32 v125, v126, v127
    ds_write_b64 v6, v[124:125] offset:4720
    s_waitcnt lgkmcnt(0)
    ds_read_b128 v[32:35], v9 offset:0
    ds_read_b128 v[36:39], v9 offset:1152
    ds_read_b128 v[40:43], v9 offset:2304
    ds_read_b128 v[44:47], v9 offset:3456
    ds_read_b128 v[48:51], v9 offset:4608
    ds_read_b128 v[52:55], v9 offset:5760
    ds_read_b128 v[56:59], v9 offset:6912
    ds_read_b128 v[60:63], v9 offset:8064
    s_waitcnt lgkmcnt(7)
    buffer_store_dwordx4 v[32:35], v7, s[12:15], s18 offen sc1
    s_add_u32 s18, s18, s19
    s_waitcnt lgkmcnt(6)
    buffer_store_dwordx4 v[36:39], v7, s[12:15], s18 offen sc1
    s_add_u32 s18, s18, s19
    s_waitcnt lgkmcnt(5)
    buffer_store_dwordx4 v[40:43], v7, s[12:15], s18 offen sc1
    s_add_u32 s18, s18, s19
    s_waitcnt lgkmcnt(4)
    buffer_store_dwordx4 v[44:47], v7, s[12:15], s18 offen sc1
    s_add_u32 s18, s18, s19
    s_waitcnt lgkmcnt(3)
    buffer_store_dwordx4 v[48:51], v7, s[12:15], s18 offen sc1
    s_add_u32 s18, s18, s19
    s_waitcnt lgkmcnt(2)
    buffer_store_dwordx4 v[52:55], v7, s[12:15], s18 offen sc1
    s_add_u32 s18, s18, s19
    s_waitcnt lgkmcnt(1)
    buffer_store_dwordx4 v[56:59], v7, s[12:15], s18 offen sc1
    s_add_u32 s18, s18, s19
    s_waitcnt lgkmcnt(0)
    buffer_store_dwordx4 v[60:63], v7, s[12:15], s18 offen sc1
    s_waitcnt vmcnt(0)
    s_barrier
    s_cmp_lg_u32 s7, 0
    s_cbranch_scc1 sg3_d
    v_mov_b32 v250, 1
    s_mov_b64 exec, 1
    buffer_atomic_add v250, off, s[96:99], s36 sc1
sg3_d:
g1_end:
    s_endpgm
att_a:
    v_lshrrev_b32 v1, 6, v0
    v_and_b32 v2, 63, v0
    s_nop 0
    v_readfirstlane_b32 s4, v1
    s_lshl_b32 s3, s2, 2
    s_add_u32 s3, s3, s4
    s_lshr_b32 s30, s3, 5
    s_and_b32 s31, s3, 31
    v_and_b32 v3, 15, v2
    v_lshrrev_b32 v4, 4, v2
    s_cmp_lg_u32 s7, 0
    s_cbranch_scc1 wt4_d
    s_mov_b32 s37, 0
wt4_l:
    buffer_load_dword v252, v250, s[96:99], 0 offen sc1
    s_waitcnt vmcnt(0)
    v_cmp_gt_u32 vcc, v251, v252
    s_nop 1
    s_cbranch_vccz wt4_d
    s_add_u32 s37, s37, 1
    s_cmp_gt_u32 s37, 0x20000
    s_cbranch_scc1 wt4_d
    s_sleep 16
    s_branch wt4_l
wt4_d:
    s_barrier
    s_lshl_b32 s20, s30, 19
    s_lshl_b32 s21, s31, 8
    s_add_u32 s20, s20, s21
    s_add_u32 s20, s20, 33554432
    s_add_u32 s21, s20, 8192
    v_lshlrev_b32 v5, 14, v3
    v_lshl_add_u32 v5, v4, 4, v5
    v_add_u32 v6, 0x40000, v5
    s_lshl_b32 s22, s3, 11
    s_add_u32 s23, s22, 161480704
    s_add_u32 s22, s22, 157286400
    s_lshl_b32 s24, s3, 13
    s_add_u32 s24, s24, 67108864
    v_and_b32 v7, 7, v2
    v_lshlrev_b32 v7, 8, v7
    v_lshl_add_u32 v7, v4, 4, v7
    v_lshlrev_b32 v8, 6, v3
    v_lshl_add_u32 v8, v4, 3, v8
    v_add_u32 v9, 4096, v8
    v_and_b32 v10, 1, v4
    v_lshlrev_b32 v10, 3, v10
    v_lshl_add_u32 v10, v3, 4, v10
    buffer_load_dwordx4 v[16:19], v5, s[96:99], s21 offen offset:0
    buffer_load_dwordx4 v[20:23], v5, s[96:99], s21 offen offset:64
    buffer_load_dwordx4 v[24:27], v5, s[96:99], s21 offen offset:128
    buffer_load_dwordx4 v[28:31], v5, s[96:99], s21 offen offset:192
    buffer_load_dwordx4 v[32:35], v6, s[96:99], s21 offen offset:0
    buffer_load_dwordx4 v[36:39], v6, s[96:99], s21 offen offset:64
    buffer_load_dwordx4 v[40:43], v6, s[96:99], s21 offen offset:128
    buffer_load_dwordx4 v[44:47], v6, s[96:99], s21 offen offset:192
    buffer_load_dwordx4 v[64:67], v5, s[96:99], s20 offen offset:0
    buffer_load_dwordx4 v[68:71], v5, s[96:99], s20 offen offset:64
    buffer_load_dwordx4 v[72:75], v5, s[96:99], s20 offen offset:128
    buffer_load_dwordx4 v[76:79], v5, s[96:99], s20 offen offset:192
    buffer_load_dwordx4 v[80:83], v6, s[96:99], s20 offen offset:0
    buffer_load_dwordx4 v[84:87], v6, s[96:99], s20 offen offset:64
    buffer_load_dwordx4 v[88:91], v6, s[96:99], s20 offen offset:128
    buffer_load_dwordx4 v[92:95], v6, s[96:99], s20 offen offset:192
    buffer_load_dwordx2 v[96:97], v8, s[96:99], s24 offen offset:0
    buffer_load_dwordx2 v[98:99], v8, s[96:99], s24 offen offset:32
    buffer_load_dwordx2 v[100:101], v8, s[96:99], s24 offen offset:1024
    buffer_load_dwordx2 v[102:103], v8, s[96:99], s24 offen offset:1056
    buffer_load_dwordx2 v[104:105], v8, s[96:99], s24 offen offset:2048
    buffer_load_dwordx2 v[106:107], v8, s[96:99], s24 offen offset:2080
    buffer_load_dwordx2 v[108:109], v8, s[96:99], s24 offen offset:3072
    buffer_load_dwordx2 v[110:111], v8, s[96:99], s24 offen offset:3104
    buffer_load_dwordx2 v[112:113], v9, s[96:99], s24 offen offset:0
    buffer_load_dwordx2 v[114:115], v9, s[96:99], s24 offen offset:32
    buffer_load_dwordx2 v[116:117], v9, s[96:99], s24 offen offset:1024
    buffer_load_dwordx2 v[118:119], v9, s[96:99], s24 offen offset:1056
    buffer_load_dwordx2 v[120:121], v9, s[96:99], s24 offen offset:2048
    buffer_load_dwordx2 v[122:123], v9, s[96:99], s24 offen offset:2080
    buffer_load_dwordx2 v[124:125], v9, s[96:99], s24 offen offset:3072
    buffer_load_dwordx2 v[126:127], v9, s[96:99], s24 offen offset:3104
    s_cmp_lg_u32 s7, 0
    s_cbranch_scc1 wt5_d
    s_mov_b32 s37, 0
wt5_l:
    buffer_load_dword v252, v253, s[96:99], 0 offen sc1
    s_waitcnt vmcnt(0)
    v_cmp_gt_u32 vcc, v254, v252
    s_nop 1
    s_cbranch_vccz wt5_d
    s_add_u32 s37, s37, 1
    s_cmp_gt_u32 s37, 0x20000
    s_cbranch_scc1 wt5_d
    s_sleep 16
    s_branch wt5_l
wt5_d:
    s_barrier
    buffer_load_dwordx4 v[48:51], v7, s[96:99], s22 offen offset:0
    buffer_load_dwordx4 v[52:55], v7, s[96:99], s22 offen offset:64
    buffer_load_dwordx4 v[56:59], v7, s[96:99], s22 offen offset:128
    buffer_load_dwordx4 v[60:63], v7, s[96:99], s22 offen offset:192
    buffer_load_dwordx2 v[128:129], v10, s[96:99], s23 offen offset:0
    buffer_load_dwordx2 v[130:131], v10, s[96:99], s23 offen offset:256
    buffer_load_dwordx2 v[132:133], v10, s[96:99], s23 offen offset:512
    buffer_load_dwordx2 v[134:135], v10, s[96:99], s23 offen offset:768
    buffer_load_dwordx2 v[136:137], v10, s[96:99], s23 offen offset:1024
    buffer_load_dwordx2 v[138:139], v10, s[96:99], s23 offen offset:1280
    buffer_load_dwordx2 v[140:141], v10, s[96:99], s23 offen offset:1536
    buffer_load_dwordx2 v[142:143], v10, s[96:99], s23 offen offset:1792
    s_lshl_b32 s26, s30, 18
    s_lshl_b32 s27, s31, 8
    s_add_u32 s26, s26, s27
    s_add_u32 s26, s26, 117440512
    v_lshlrev_b32 v11, 13, v3
    v_lshl_add_u32 v11, v4, 3, v11
    s_waitcnt vmcnt(0)
    v_add_u32 v12, 0, v3
    v_mfma_f32_16x16x32_bf16 v[144:147], v[16:19], v[64:67], 0
    v_mfma_f32_16x16x32_bf16 v[148:151], v[32:35], v[64:67], 0
    v_mfma_f32_16x16x32_bf16 v[152:155], v[48:51], v[64:67], 0
    v_mfma_f32_16x16x32_bf16 v[144:147], v[20:23], v[68:71], v[144:147]
    v_mfma_f32_16x16x32_bf16 v[148:151], v[36:39], v[68:71], v[148:151]
    v_mfma_f32_16x16x32_bf16 v[152:155], v[52:55], v[68:71], v[152:155]
    v_mfma_f32_16x16x32_bf16 v[144:147], v[24:27], v[72:75], v[144:147]
    v_mfma_f32_16x16x32_bf16 v[148:151], v[40:43], v[72:75], v[148:151]
    v_mfma_f32_16x16x32_bf16 v[152:155], v[56:59], v[72:75], v[152:155]
    v_mfma_f32_16x16x32_bf16 v[144:147], v[28:31], v[76:79], v[144:147]
    v_mfma_f32_16x16x32_bf16 v[148:151], v[44:47], v[76:79], v[148:151]
    v_mfma_f32_16x16x32_bf16 v[152:155], v[60:63], v[76:79], v[152:155]
    s_mov_b32 s35, 0x3db504f3
    v_mov_b32 v164, 0xce6e6b28
    v_cmp_gt_u32 s[40:41], 2, v4
    v_lshlrev_b32 v165, 2, v4
    s_nop 5
    v_cvt_pk_bf16_f32 v144, v144, v144
    v_and_b32 v144, 0xffff0000, v144
    v_mul_f32 v144, s35, v144
    v_cvt_pk_bf16_f32 v144, v144, v144
    v_and_b32 v144, 0xffff0000, v144
    v_cvt_pk_bf16_f32 v145, v145, v145
    v_and_b32 v145, 0xffff0000, v145
    v_mul_f32 v145, s35, v145
    v_cvt_pk_bf16_f32 v145, v145, v145
    v_and_b32 v145, 0xffff0000, v145
    v_cvt_pk_bf16_f32 v146, v146, v146
    v_and_b32 v146, 0xffff0000, v146
    v_mul_f32 v146, s35, v146
    v_cvt_pk_bf16_f32 v146, v146, v146
    v_and_b32 v146, 0xffff0000, v146
    v_cvt_pk_bf16_f32 v147, v147, v147
    v_and_b32 v147, 0xffff0000, v147
    v_mul_f32 v147, s35, v147
    v_cvt_pk_bf16_f32 v147, v147, v147
    v_and_b32 v147, 0xffff0000, v147
    v_cvt_pk_bf16_f32 v148, v148, v148
    v_and_b32 v148, 0xffff0000, v148
    v_mul_f32 v148, s35, v148
    v_cvt_pk_bf16_f32 v148, v148, v148
    v_and_b32 v148, 0xffff0000, v148
    v_cvt_pk_bf16_f32 v149, v149, v149
    v_and_b32 v149, 0xffff0000, v149
    v_mul_f32 v149, s35, v149
    v_cvt_pk_bf16_f32 v149, v149, v149
    v_and_b32 v149, 0xffff0000, v149
    v_cvt_pk_bf16_f32 v150, v150, v150
    v_and_b32 v150, 0xffff0000, v150
    v_mul_f32 v150, s35, v150
    v_cvt_pk_bf16_f32 v150, v150, v150
    v_and_b32 v150, 0xffff0000, v150
    v_cvt_pk_bf16_f32 v151, v151, v151
    v_and_b32 v151, 0xffff0000, v151
    v_mul_f32 v151, s35, v151
    v_cvt_pk_bf16_f32 v151, v151, v151
    v_and_b32 v151, 0xffff0000, v151
    v_cvt_pk_bf16_f32 v152, v152, v152
    v_and_b32 v152, 0xffff0000, v152
    v_mul_f32 v152, s35, v152
    v_cvt_pk_bf16_f32 v152, v152, v152
    v_and_b32 v152, 0xffff0000, v152
    v_cvt_pk_bf16_f32 v153, v153, v153
    v_and_b32 v153, 0xffff0000, v153
    v_mul_f32 v153, s35, v153
    v_cvt_pk_bf16_f32 v153, v153, v153
    v_and_b32 v153, 0xffff0000, v153
    v_cvt_pk_bf16_f32 v154, v154, v154
    v_and_b32 v154, 0xffff0000, v154
    v_mul_f32 v154, s35, v154
    v_cvt_pk_bf16_f32 v154, v154, v154
    v_and_b32 v154, 0xffff0000, v154
    v_cvt_pk_bf16_f32 v155, v155, v155
    v_and_b32 v155, 0xffff0000, v155
    v_mul_f32 v155, s35, v155
    v_cvt_pk_bf16_f32 v155, v155, v155
    v_and_b32 v155, 0xffff0000, v155
    v_cndmask_b32 v152, v164, v152, s[40:41]
    v_cndmask_b32 v153, v164, v153, s[40:41]
    v_cndmask_b32 v154, v164, v154, s[40:41]
    v_cndmask_b32 v155, v164, v155, s[40:41]
    v_add_u32 v166, 0, v165
    v_cmp_le_u32 vcc, v166, v12
    s_nop 1
    v_cndmask_b32 v144, v164, v144, vcc
    v_add_u32 v166, 1, v165
    v_cmp_le_u32 vcc, v166, v12
    s_nop 1
    v_cndmask_b32 v145, v164, v145, vcc
    v_add_u32 v166, 2, v165
    v_cmp_le_u32 vcc, v166, v12
    s_nop 1
    v_cndmask_b32 v146, v164, v146, vcc
    v_add_u32 v166, 3, v165
    v_cmp_le_u32 vcc, v166, v12
    s_nop 1
    v_cndmask_b32 v147, v164, v147, vcc
    v_add_u32 v166, 16, v165
    v_cmp_le_u32 vcc, v166, v12
    s_nop 1
    v_cndmask_b32 v148, v164, v148, vcc
    v_add_u32 v166, 17, v165
    v_cmp_le_u32 vcc, v166, v12
    s_nop 1
    v_cndmask_b32 v149, v164, v149, vcc
    v_add_u32 v166, 18, v165
    v_cmp_le_u32 vcc, v166, v12
    s_nop 1
    v_cndmask_b32 v150, v164, v150, vcc
    v_add_u32 v166, 19, v165
    v_cmp_le_u32 vcc, v166, v12
    s_nop 1
    v_cndmask_b32 v151, v164, v151, vcc
    v_max3_f32 v164, v144, v145, v146
    v_max3_f32 v164, v164, v147, v148
    v_max3_f32 v164, v164, v149, v150
    v_max3_f32 v164, v164, v151, v152
    v_max3_f32 v164, v164, v153, v154
    v_max_f32 v164, v164, v155
    v_mov_b32 v165, v164
    s_nop 1
    v_permlane32_swap_b32 v164, v165
    s_nop 1
    v_max_f32 v164, v164, v165
    v_mov_b32 v165, v164
    s_nop 1
    v_permlane16_swap_b32 v164, v165
    s_nop 1
    v_max_f32 v164, v164, v165
    s_mov_b32 s35, 0x3fb8aa3b
    v_sub_f32 v144, v144, v164
    v_mul_f32 v144, s35, v144
    v_exp_f32 v144, v144
    v_sub_f32 v145, v145, v164
    v_mul_f32 v145, s35, v145
    v_exp_f32 v145, v145
    v_sub_f32 v146, v146, v164
    v_mul_f32 v146, s35, v146
    v_exp_f32 v146, v146
    v_sub_f32 v147, v147, v164
    v_mul_f32 v147, s35, v147
    v_exp_f32 v147, v147
    v_sub_f32 v148, v148, v164
    v_mul_f32 v148, s35, v148
    v_exp_f32 v148, v148
    v_sub_f32 v149, v149, v164
    v_mul_f32 v149, s35, v149
    v_exp_f32 v149, v149
    v_sub_f32 v150, v150, v164
    v_mul_f32 v150, s35, v150
    v_exp_f32 v150, v150
    v_sub_f32 v151, v151, v164
    v_mul_f32 v151, s35, v151
    v_exp_f32 v151, v151
    v_sub_f32 v152, v152, v164
    v_mul_f32 v152, s35, v152
    v_exp_f32 v152, v152
    v_sub_f32 v153, v153, v164
    v_mul_f32 v153, s35, v153
    v_exp_f32 v153, v153
    v_sub_f32 v154, v154, v164
    v_mul_f32 v154, s35, v154
    v_exp_f32 v154, v154
    v_sub_f32 v155, v155, v164
    v_mul_f32 v155, s35, v155
    v_exp_f32 v155, v155
    s_nop 0
    v_add_f32 v166, v144, v145
    v_add_f32 v167, v146, v147
    v_add_f32 v166, v166, v148
    v_add_f32 v167, v167, v149
    v_add_f32 v166, v166, v150
    v_add_f32 v167, v167, v151
    v_add_f32 v166, v166, v152
    v_add_f32 v167, v167, v153
    v_add_f32 v166, v166, v154
    v_add_f32 v167, v167, v155
    v_add_f32 v164, v166, v167
    v_mov_b32 v165, v164
    s_nop 1
    v_permlane32_swap_b32 v164, v165
    s_nop 1
    v_add_f32 v164, v164, v165
    v_mov_b32 v165, v164
    s_nop 1
    v_permlane16_swap_b32 v164, v165
    s_nop 1
    v_add_f32 v164, v164, v165
    v_rcp_f32 v164, v164
    s_nop 0
    v_mul_f32 v144, v144, v164
    v_mul_f32 v145, v145, v164
    v_mul_f32 v146, v146, v164
    v_mul_f32 v147, v147, v164
    v_mul_f32 v148, v148, v164
    v_mul_f32 v149, v149, v164
    v_mul_f32 v150, v150, v164
    v_mul_f32 v151, v151, v164
    v_mul_f32 v152, v152, v164
    v_mul_f32 v153, v153, v164
    v_mul_f32 v154, v154, v164
    v_mul_f32 v155, v155, v164
    v_cvt_pk_bf16_f32 v156, v144, v145
    v_cvt_pk_bf16_f32 v157, v146, v147
    v_cvt_pk_bf16_f32 v158, v148, v149
    v_cvt_pk_bf16_f32 v159, v150, v151
    v_cvt_pk_bf16_f32 v160, v152, v153
    v_cvt_pk_bf16_f32 v161, v154, v155
    s_nop 1
    v_mfma_f32_16x16x32_bf16 v[168:171], v[96:99], v[156:159], 0
    v_mfma_f32_16x16x32_bf16 v[172:175], v[100:103], v[156:159], 0
    v_mfma_f32_16x16x32_bf16 v[176:179], v[104:107], v[156:159], 0
    v_mfma_f32_16x16x32_bf16 v[180:183], v[108:111], v[156:159], 0
    v_mfma_f32_16x16x32_bf16 v[184:187], v[112:115], v[156:159], 0
    v_mfma_f32_16x16x32_bf16 v[188:191], v[116:119], v[156:159], 0
    v_mfma_f32_16x16x32_bf16 v[192:195], v[120:123], v[156:159], 0
    v_mfma_f32_16x16x32_bf16 v[196:199], v[124:127], v[156:159], 0
    v_mfma_f32_16x16x16_bf16 v[168:171], v[128:129], v[160:161], v[168:171]
    v_mfma_f32_16x16x16_bf16 v[172:175], v[130:131], v[160:161], v[172:175]
    v_mfma_f32_16x16x16_bf16 v[176:179], v[132:133], v[160:161], v[176:179]
    v_mfma_f32_16x16x16_bf16 v[180:183], v[134:135], v[160:161], v[180:183]
    v_mfma_f32_16x16x16_bf16 v[184:187], v[136:137], v[160:161], v[184:187]
    v_mfma_f32_16x16x16_bf16 v[188:191], v[138:139], v[160:161], v[188:191]
    v_mfma_f32_16x16x16_bf16 v[192:195], v[140:141], v[160:161], v[192:195]
    v_mfma_f32_16x16x16_bf16 v[196:199], v[142:143], v[160:161], v[196:199]
    s_nop 7
    v_cvt_pk_bf16_f32 v168, v168, v169
    v_cvt_pk_bf16_f32 v169, v170, v171
    buffer_store_dwordx2 v[168:169], v11, s[96:99], s26 offen offset:0 sc1
    v_cvt_pk_bf16_f32 v172, v172, v173
    v_cvt_pk_bf16_f32 v173, v174, v175
    buffer_store_dwordx2 v[172:173], v11, s[96:99], s26 offen offset:32 sc1
    v_cvt_pk_bf16_f32 v176, v176, v177
    v_cvt_pk_bf16_f32 v177, v178, v179
    buffer_store_dwordx2 v[176:177], v11, s[96:99], s26 offen offset:64 sc1
    v_cvt_pk_bf16_f32 v180, v180, v181
    v_cvt_pk_bf16_f32 v181, v182, v183
    buffer_store_dwordx2 v[180:181], v11, s[96:99], s26 offen offset:96 sc1
    v_cvt_pk_bf16_f32 v184, v184, v185
    v_cvt_pk_bf16_f32 v185, v186, v187
    buffer_store_dwordx2 v[184:185], v11, s[96:99], s26 offen offset:128 sc1
    v_cvt_pk_bf16_f32 v188, v188, v189
    v_cvt_pk_bf16_f32 v189, v190, v191
    buffer_store_dwordx2 v[188:189], v11, s[96:99], s26 offen offset:160 sc1
    v_cvt_pk_bf16_f32 v192, v192, v193
    v_cvt_pk_bf16_f32 v193, v194, v195
    buffer_store_dwordx2 v[192:193], v11, s[96:99], s26 offen offset:192 sc1
    v_cvt_pk_bf16_f32 v196, v196, v197
    v_cvt_pk_bf16_f32 v197, v198, v199
    buffer_store_dwordx2 v[196:197], v11, s[96:99], s26 offen offset:224 sc1
    v_add_u32 v11, 0x20000, v11
    s_nop 4
    v_add_u32 v12, 16, v3
    v_mfma_f32_16x16x32_bf16 v[144:147], v[16:19], v[80:83], 0
    v_mfma_f32_16x16x32_bf16 v[148:151], v[32:35], v[80:83], 0
    v_mfma_f32_16x16x32_bf16 v[152:155], v[48:51], v[80:83], 0
    v_mfma_f32_16x16x32_bf16 v[144:147], v[20:23], v[84:87], v[144:147]
    v_mfma_f32_16x16x32_bf16 v[148:151], v[36:39], v[84:87], v[148:151]
    v_mfma_f32_16x16x32_bf16 v[152:155], v[52:55], v[84:87], v[152:155]
    v_mfma_f32_16x16x32_bf16 v[144:147], v[24:27], v[88:91], v[144:147]
    v_mfma_f32_16x16x32_bf16 v[148:151], v[40:43], v[88:91], v[148:151]
    v_mfma_f32_16x16x32_bf16 v[152:155], v[56:59], v[88:91], v[152:155]
    v_mfma_f32_16x16x32_bf16 v[144:147], v[28:31], v[92:95], v[144:147]
    v_mfma_f32_16x16x32_bf16 v[148:151], v[44:47], v[92:95], v[148:151]
    v_mfma_f32_16x16x32_bf16 v[152:155], v[60:63], v[92:95], v[152:155]
    s_mov_b32 s35, 0x3db504f3
    v_mov_b32 v164, 0xce6e6b28
    v_cmp_gt_u32 s[40:41], 2, v4
    v_lshlrev_b32 v165, 2, v4
    s_nop 5
    v_cvt_pk_bf16_f32 v144, v144, v144
    v_and_b32 v144, 0xffff0000, v144
    v_mul_f32 v144, s35, v144
    v_cvt_pk_bf16_f32 v144, v144, v144
    v_and_b32 v144, 0xffff0000, v144
    v_cvt_pk_bf16_f32 v145, v145, v145
    v_and_b32 v145, 0xffff0000, v145
    v_mul_f32 v145, s35, v145
    v_cvt_pk_bf16_f32 v145, v145, v145
    v_and_b32 v145, 0xffff0000, v145
    v_cvt_pk_bf16_f32 v146, v146, v146
    v_and_b32 v146, 0xffff0000, v146
    v_mul_f32 v146, s35, v146
    v_cvt_pk_bf16_f32 v146, v146, v146
    v_and_b32 v146, 0xffff0000, v146
    v_cvt_pk_bf16_f32 v147, v147, v147
    v_and_b32 v147, 0xffff0000, v147
    v_mul_f32 v147, s35, v147
    v_cvt_pk_bf16_f32 v147, v147, v147
    v_and_b32 v147, 0xffff0000, v147
    v_cvt_pk_bf16_f32 v148, v148, v148
    v_and_b32 v148, 0xffff0000, v148
    v_mul_f32 v148, s35, v148
    v_cvt_pk_bf16_f32 v148, v148, v148
    v_and_b32 v148, 0xffff0000, v148
    v_cvt_pk_bf16_f32 v149, v149, v149
    v_and_b32 v149, 0xffff0000, v149
    v_mul_f32 v149, s35, v149
    v_cvt_pk_bf16_f32 v149, v149, v149
    v_and_b32 v149, 0xffff0000, v149
    v_cvt_pk_bf16_f32 v150, v150, v150
    v_and_b32 v150, 0xffff0000, v150
    v_mul_f32 v150, s35, v150
    v_cvt_pk_bf16_f32 v150, v150, v150
    v_and_b32 v150, 0xffff0000, v150
    v_cvt_pk_bf16_f32 v151, v151, v151
    v_and_b32 v151, 0xffff0000, v151
    v_mul_f32 v151, s35, v151
    v_cvt_pk_bf16_f32 v151, v151, v151
    v_and_b32 v151, 0xffff0000, v151
    v_cvt_pk_bf16_f32 v152, v152, v152
    v_and_b32 v152, 0xffff0000, v152
    v_mul_f32 v152, s35, v152
    v_cvt_pk_bf16_f32 v152, v152, v152
    v_and_b32 v152, 0xffff0000, v152
    v_cvt_pk_bf16_f32 v153, v153, v153
    v_and_b32 v153, 0xffff0000, v153
    v_mul_f32 v153, s35, v153
    v_cvt_pk_bf16_f32 v153, v153, v153
    v_and_b32 v153, 0xffff0000, v153
    v_cvt_pk_bf16_f32 v154, v154, v154
    v_and_b32 v154, 0xffff0000, v154
    v_mul_f32 v154, s35, v154
    v_cvt_pk_bf16_f32 v154, v154, v154
    v_and_b32 v154, 0xffff0000, v154
    v_cvt_pk_bf16_f32 v155, v155, v155
    v_and_b32 v155, 0xffff0000, v155
    v_mul_f32 v155, s35, v155
    v_cvt_pk_bf16_f32 v155, v155, v155
    v_and_b32 v155, 0xffff0000, v155
    v_cndmask_b32 v152, v164, v152, s[40:41]
    v_cndmask_b32 v153, v164, v153, s[40:41]
    v_cndmask_b32 v154, v164, v154, s[40:41]
    v_cndmask_b32 v155, v164, v155, s[40:41]
    v_add_u32 v166, 0, v165
    v_cmp_le_u32 vcc, v166, v12
    s_nop 1
    v_cndmask_b32 v144, v164, v144, vcc
    v_add_u32 v166, 1, v165
    v_cmp_le_u32 vcc, v166, v12
    s_nop 1
    v_cndmask_b32 v145, v164, v145, vcc
    v_add_u32 v166, 2, v165
    v_cmp_le_u32 vcc, v166, v12
    s_nop 1
    v_cndmask_b32 v146, v164, v146, vcc
    v_add_u32 v166, 3, v165
    v_cmp_le_u32 vcc, v166, v12
    s_nop 1
    v_cndmask_b32 v147, v164, v147, vcc
    v_add_u32 v166, 16, v165
    v_cmp_le_u32 vcc, v166, v12
    s_nop 1
    v_cndmask_b32 v148, v164, v148, vcc
    v_add_u32 v166, 17, v165
    v_cmp_le_u32 vcc, v166, v12
    s_nop 1
    v_cndmask_b32 v149, v164, v149, vcc
    v_add_u32 v166, 18, v165
    v_cmp_le_u32 vcc, v166, v12
    s_nop 1
    v_cndmask_b32 v150, v164, v150, vcc
    v_add_u32 v166, 19, v165
    v_cmp_le_u32 vcc, v166, v12
    s_nop 1
    v_cndmask_b32 v151, v164, v151, vcc
    v_max3_f32 v164, v144, v145, v146
    v_max3_f32 v164, v164, v147, v148
    v_max3_f32 v164, v164, v149, v150
    v_max3_f32 v164, v164, v151, v152
    v_max3_f32 v164, v164, v153, v154
    v_max_f32 v164, v164, v155
    v_mov_b32 v165, v164
    s_nop 1
    v_permlane32_swap_b32 v164, v165
    s_nop 1
    v_max_f32 v164, v164, v165
    v_mov_b32 v165, v164
    s_nop 1
    v_permlane16_swap_b32 v164, v165
    s_nop 1
    v_max_f32 v164, v164, v165
    s_mov_b32 s35, 0x3fb8aa3b
    v_sub_f32 v144, v144, v164
    v_mul_f32 v144, s35, v144
    v_exp_f32 v144, v144
    v_sub_f32 v145, v145, v164
    v_mul_f32 v145, s35, v145
    v_exp_f32 v145, v145
    v_sub_f32 v146, v146, v164
    v_mul_f32 v146, s35, v146
    v_exp_f32 v146, v146
    v_sub_f32 v147, v147, v164
    v_mul_f32 v147, s35, v147
    v_exp_f32 v147, v147
    v_sub_f32 v148, v148, v164
    v_mul_f32 v148, s35, v148
    v_exp_f32 v148, v148
    v_sub_f32 v149, v149, v164
    v_mul_f32 v149, s35, v149
    v_exp_f32 v149, v149
    v_sub_f32 v150, v150, v164
    v_mul_f32 v150, s35, v150
    v_exp_f32 v150, v150
    v_sub_f32 v151, v151, v164
    v_mul_f32 v151, s35, v151
    v_exp_f32 v151, v151
    v_sub_f32 v152, v152, v164
    v_mul_f32 v152, s35, v152
    v_exp_f32 v152, v152
    v_sub_f32 v153, v153, v164
    v_mul_f32 v153, s35, v153
    v_exp_f32 v153, v153
    v_sub_f32 v154, v154, v164
    v_mul_f32 v154, s35, v154
    v_exp_f32 v154, v154
    v_sub_f32 v155, v155, v164
    v_mul_f32 v155, s35, v155
    v_exp_f32 v155, v155
    s_nop 0
    v_add_f32 v166, v144, v145
    v_add_f32 v167, v146, v147
    v_add_f32 v166, v166, v148
    v_add_f32 v167, v167, v149
    v_add_f32 v166, v166, v150
    v_add_f32 v167, v167, v151
    v_add_f32 v166, v166, v152
    v_add_f32 v167, v167, v153
    v_add_f32 v166, v166, v154
    v_add_f32 v167, v167, v155
    v_add_f32 v164, v166, v167
    v_mov_b32 v165, v164
    s_nop 1
    v_permlane32_swap_b32 v164, v165
    s_nop 1
    v_add_f32 v164, v164, v165
    v_mov_b32 v165, v164
    s_nop 1
    v_permlane16_swap_b32 v164, v165
    s_nop 1
    v_add_f32 v164, v164, v165
    v_rcp_f32 v164, v164
    s_nop 0
    v_mul_f32 v144, v144, v164
    v_mul_f32 v145, v145, v164
    v_mul_f32 v146, v146, v164
    v_mul_f32 v147, v147, v164
    v_mul_f32 v148, v148, v164
    v_mul_f32 v149, v149, v164
    v_mul_f32 v150, v150, v164
    v_mul_f32 v151, v151, v164
    v_mul_f32 v152, v152, v164
    v_mul_f32 v153, v153, v164
    v_mul_f32 v154, v154, v164
    v_mul_f32 v155, v155, v164
    v_cvt_pk_bf16_f32 v156, v144, v145
    v_cvt_pk_bf16_f32 v157, v146, v147
    v_cvt_pk_bf16_f32 v158, v148, v149
    v_cvt_pk_bf16_f32 v159, v150, v151
    v_cvt_pk_bf16_f32 v160, v152, v153
    v_cvt_pk_bf16_f32 v161, v154, v155
    s_nop 1
    v_mfma_f32_16x16x32_bf16 v[168:171], v[96:99], v[156:159], 0
    v_mfma_f32_16x16x32_bf16 v[172:175], v[100:103], v[156:159], 0
    v_mfma_f32_16x16x32_bf16 v[176:179], v[104:107], v[156:159], 0
    v_mfma_f32_16x16x32_bf16 v[180:183], v[108:111], v[156:159], 0
    v_mfma_f32_16x16x32_bf16 v[184:187], v[112:115], v[156:159], 0
    v_mfma_f32_16x16x32_bf16 v[188:191], v[116:119], v[156:159], 0
    v_mfma_f32_16x16x32_bf16 v[192:195], v[120:123], v[156:159], 0
    v_mfma_f32_16x16x32_bf16 v[196:199], v[124:127], v[156:159], 0
    v_mfma_f32_16x16x16_bf16 v[168:171], v[128:129], v[160:161], v[168:171]
    v_mfma_f32_16x16x16_bf16 v[172:175], v[130:131], v[160:161], v[172:175]
    v_mfma_f32_16x16x16_bf16 v[176:179], v[132:133], v[160:161], v[176:179]
    v_mfma_f32_16x16x16_bf16 v[180:183], v[134:135], v[160:161], v[180:183]
    v_mfma_f32_16x16x16_bf16 v[184:187], v[136:137], v[160:161], v[184:187]
    v_mfma_f32_16x16x16_bf16 v[188:191], v[138:139], v[160:161], v[188:191]
    v_mfma_f32_16x16x16_bf16 v[192:195], v[140:141], v[160:161], v[192:195]
    v_mfma_f32_16x16x16_bf16 v[196:199], v[142:143], v[160:161], v[196:199]
    s_nop 7
    v_cvt_pk_bf16_f32 v168, v168, v169
    v_cvt_pk_bf16_f32 v169, v170, v171
    buffer_store_dwordx2 v[168:169], v11, s[96:99], s26 offen offset:0 sc1
    v_cvt_pk_bf16_f32 v172, v172, v173
    v_cvt_pk_bf16_f32 v173, v174, v175
    buffer_store_dwordx2 v[172:173], v11, s[96:99], s26 offen offset:32 sc1
    v_cvt_pk_bf16_f32 v176, v176, v177
    v_cvt_pk_bf16_f32 v177, v178, v179
    buffer_store_dwordx2 v[176:177], v11, s[96:99], s26 offen offset:64 sc1
    v_cvt_pk_bf16_f32 v180, v180, v181
    v_cvt_pk_bf16_f32 v181, v182, v183
    buffer_store_dwordx2 v[180:181], v11, s[96:99], s26 offen offset:96 sc1
    v_cvt_pk_bf16_f32 v184, v184, v185
    v_cvt_pk_bf16_f32 v185, v186, v187
    buffer_store_dwordx2 v[184:185], v11, s[96:99], s26 offen offset:128 sc1
    v_cvt_pk_bf16_f32 v188, v188, v189
    v_cvt_pk_bf16_f32 v189, v190, v191
    buffer_store_dwordx2 v[188:189], v11, s[96:99], s26 offen offset:160 sc1
    v_cvt_pk_bf16_f32 v192, v192, v193
    v_cvt_pk_bf16_f32 v193, v194, v195
    buffer_store_dwordx2 v[192:193], v11, s[96:99], s26 offen offset:192 sc1
    v_cvt_pk_bf16_f32 v196, v196, v197
    v_cvt_pk_bf16_f32 v197, v198, v199
    buffer_store_dwordx2 v[196:197], v11, s[96:99], s26 offen offset:224 sc1
    s_branch att_end
att_b:
    s_cmp_lg_u32 s7, 0
    s_cbranch_scc1 wt6_d
    s_mov_b32 s37, 0
wt6_l:
    buffer_load_dword v252, v250, s[96:99], 0 offen sc1
    s_waitcnt vmcnt(0)
    v_cmp_gt_u32 vcc, v251, v252
    s_nop 1
    s_cbranch_vccz wt6_d
    s_add_u32 s37, s37, 1
    s_cmp_gt_u32 s37, 0x20000
    s_cbranch_scc1 wt6_d
    s_sleep 16
    s_branch wt6_l
wt6_d:
    s_barrier
    s_mov_b32 s3, s2
    s_lshl_b32 s3, s3, 8
    v_add_u32 v1, s3, v0
    v_lshrrev_b32 v2, 5, v1
    v_and_b32 v3, 31, v1
    v_mul_u32_u24 v4, 40, v3
    v_mul_u32_u24 v5, 3840, v2
    v_add_u32 v5, v5, v4
    v_add_u32 v5, 100663296, v5
    buffer_load_dword v10, v5, s[96:99], 0 offen offset:0
    buffer_load_dword v11, v5, s[96:99], 0 offen offset:4
    buffer_load_dword v12, v5, s[96:99], 0 offen offset:8
    buffer_load_dword v13, v5, s[96:99], 0 offen offset:12
    buffer_load_dword v14, v5, s[96:99], 0 offen offset:16
    buffer_load_dword v15, v5, s[96:99], 0 offen offset:20
    buffer_load_dword v16, v5, s[96:99], 0 offen offset:24
    buffer_load_dword v17, v5, s[96:99], 0 offen offset:28
    buffer_load_dword v18, v5, s[96:99], 0 offen offset:32
    buffer_load_dword v19, v5, s[96:99], 0 offen offset:36
    s_waitcnt vmcnt(0)
    v_lshlrev_b32 v20, 16, v10
    v_and_b32 v21, 0xffff0000, v10
    v_lshlrev_b32 v22, 16, v11
    v_and_b32 v23, 0xffff0000, v11
    v_lshlrev_b32 v24, 16, v12
    v_and_b32 v25, 0xffff0000, v12
    v_lshlrev_b32 v26, 16, v13
    v_and_b32 v27, 0xffff0000, v13
    v_lshlrev_b32 v28, 16, v14
    v_and_b32 v29, 0xffff0000, v14
    v_lshlrev_b32 v30, 16, v15
    v_and_b32 v31, 0xffff0000, v15
    v_lshlrev_b32 v32, 16, v16
    v_and_b32 v33, 0xffff0000, v16
    v_lshlrev_b32 v34, 16, v17
    v_and_b32 v35, 0xffff0000, v17
    v_lshlrev_b32 v36, 16, v18
    v_and_b32 v37, 0xffff0000, v18
    v_lshlrev_b32 v38, 16, v19
    v_and_b32 v39, 0xffff0000, v19
    s_mov_b32 s35, 0x3e64f92e
    v_mov_b32 v9, 0xce6e6b28
    v_subrev_u32 v6, 0, v2
    v_cmp_le_u32 s[40:41], 0, v2
    s_nop 1
    v_cndmask_b32 v6, 0, v6, s[40:41]
    v_mul_u32_u24 v7, 3840, v6
    v_add_u32 v7, v7, v4
    v_add_u32 v7, 100663296, v7
    buffer_load_dword v10, v7, s[96:99], 0 offen offset:1280
    buffer_load_dword v11, v7, s[96:99], 0 offen offset:1284
    buffer_load_dword v12, v7, s[96:99], 0 offen offset:1288
    buffer_load_dword v13, v7, s[96:99], 0 offen offset:1292
    buffer_load_dword v14, v7, s[96:99], 0 offen offset:1296
    buffer_load_dword v15, v7, s[96:99], 0 offen offset:1300
    buffer_load_dword v16, v7, s[96:99], 0 offen offset:1304
    buffer_load_dword v17, v7, s[96:99], 0 offen offset:1308
    buffer_load_dword v18, v7, s[96:99], 0 offen offset:1312
    buffer_load_dword v19, v7, s[96:99], 0 offen offset:1316
    buffer_load_dword v60, v7, s[96:99], 0 offen offset:2560
    buffer_load_dword v61, v7, s[96:99], 0 offen offset:2564
    buffer_load_dword v62, v7, s[96:99], 0 offen offset:2568
    buffer_load_dword v63, v7, s[96:99], 0 offen offset:2572
    buffer_load_dword v64, v7, s[96:99], 0 offen offset:2576
    buffer_load_dword v65, v7, s[96:99], 0 offen offset:2580
    buffer_load_dword v66, v7, s[96:99], 0 offen offset:2584
    buffer_load_dword v67, v7, s[96:99], 0 offen offset:2588
    buffer_load_dword v68, v7, s[96:99], 0 offen offset:2592
    buffer_load_dword v69, v7, s[96:99], 0 offen offset:2596
    s_waitcnt vmcnt(10)
    v_mov_b32 v50, 0
    v_lshlrev_b32 v8, 16, v10
    v_fma_f32 v50, v8, v20, v50
    v_and_b32 v8, 0xffff0000, v10
    v_fma_f32 v50, v8, v21, v50
    v_lshlrev_b32 v8, 16, v11
    v_fma_f32 v50, v8, v22, v50
    v_and_b32 v8, 0xffff0000, v11
    v_fma_f32 v50, v8, v23, v50
    v_lshlrev_b32 v8, 16, v12
    v_fma_f32 v50, v8, v24, v50
    v_and_b32 v8, 0xffff0000, v12
    v_fma_f32 v50, v8, v25, v50
    v_lshlrev_b32 v8, 16, v13
    v_fma_f32 v50, v8, v26, v50
    v_and_b32 v8, 0xffff0000, v13
    v_fma_f32 v50, v8, v27, v50
    v_lshlrev_b32 v8, 16, v14
    v_fma_f32 v50, v8, v28, v50
    v_and_b32 v8, 0xffff0000, v14
    v_fma_f32 v50, v8, v29, v50
    v_lshlrev_b32 v8, 16, v15
    v_fma_f32 v50, v8, v30, v50
    v_and_b32 v8, 0xffff0000, v15
    v_fma_f32 v50, v8, v31, v50
    v_lshlrev_b32 v8, 16, v16
    v_fma_f32 v50, v8, v32, v50
    v_and_b32 v8, 0xffff0000, v16
    v_fma_f32 v50, v8, v33, v50
    v_lshlrev_b32 v8, 16, v17
    v_fma_f32 v50, v8, v34, v50
    v_and_b32 v8, 0xffff0000, v17
    v_fma_f32 v50, v8, v35, v50
    v_lshlrev_b32 v8, 16, v18
    v_fma_f32 v50, v8, v36, v50
    v_and_b32 v8, 0xffff0000, v18
    v_fma_f32 v50, v8, v37, v50
    v_lshlrev_b32 v8, 16, v19
    v_fma_f32 v50, v8, v38, v50
    v_and_b32 v8, 0xffff0000, v19
    v_fma_f32 v50, v8, v39, v50
    v_cvt_pk_bf16_f32 v50, v50, v50
    v_and_b32 v50, 0xffff0000, v50
    v_mul_f32 v50, s35, v50
    v_cvt_pk_bf16_f32 v50, v50, v50
    v_and_b32 v50, 0xffff0000, v50
    v_cndmask_b32 v50, v9, v50, s[40:41]
    v_subrev_u32 v6, 2, v2
    v_cmp_le_u32 s[40:41], 2, v2
    s_nop 1
    v_cndmask_b32 v6, 0, v6, s[40:41]
    v_mul_u32_u24 v7, 3840, v6
    v_add_u32 v7, v7, v4
    v_add_u32 v7, 100663296, v7
    buffer_load_dword v10, v7, s[96:99], 0 offen offset:1280
    buffer_load_dword v11, v7, s[96:99], 0 offen offset:1284
    buffer_load_dword v12, v7, s[96:99], 0 offen offset:1288
    buffer_load_dword v13, v7, s[96:99], 0 offen offset:1292
    buffer_load_dword v14, v7, s[96:99], 0 offen offset:1296
    buffer_load_dword v15, v7, s[96:99], 0 offen offset:1300
    buffer_load_dword v16, v7, s[96:99], 0 offen offset:1304
    buffer_load_dword v17, v7, s[96:99], 0 offen offset:1308
    buffer_load_dword v18, v7, s[96:99], 0 offen offset:1312
    buffer_load_dword v19, v7, s[96:99], 0 offen offset:1316
    buffer_load_dword v70, v7, s[96:99], 0 offen offset:2560
    buffer_load_dword v71, v7, s[96:99], 0 offen offset:2564
    buffer_load_dword v72, v7, s[96:99], 0 offen offset:2568
    buffer_load_dword v73, v7, s[96:99], 0 offen offset:2572
    buffer_load_dword v74, v7, s[96:99], 0 offen offset:2576
    buffer_load_dword v75, v7, s[96:99], 0 offen offset:2580
    buffer_load_dword v76, v7, s[96:99], 0 offen offset:2584
    buffer_load_dword v77, v7, s[96:99], 0 offen offset:2588
    buffer_load_dword v78, v7, s[96:99], 0 offen offset:2592
    buffer_load_dword v79, v7, s[96:99], 0 offen offset:2596
    s_waitcnt vmcnt(10)
    v_mov_b32 v51, 0
    v_lshlrev_b32 v8, 16, v10
    v_fma_f32 v51, v8, v20, v51
    v_and_b32 v8, 0xffff0000, v10
    v_fma_f32 v51, v8, v21, v51
    v_lshlrev_b32 v8, 16, v11
    v_fma_f32 v51, v8, v22, v51
    v_and_b32 v8, 0xffff0000, v11
    v_fma_f32 v51, v8, v23, v51
    v_lshlrev_b32 v8, 16, v12
    v_fma_f32 v51, v8, v24, v51
    v_and_b32 v8, 0xffff0000, v12
    v_fma_f32 v51, v8, v25, v51
    v_lshlrev_b32 v8, 16, v13
    v_fma_f32 v51, v8, v26, v51
    v_and_b32 v8, 0xffff0000, v13
    v_fma_f32 v51, v8, v27, v51
    v_lshlrev_b32 v8, 16, v14
    v_fma_f32 v51, v8, v28, v51
    v_and_b32 v8, 0xffff0000, v14
    v_fma_f32 v51, v8, v29, v51
    v_lshlrev_b32 v8, 16, v15
    v_fma_f32 v51, v8, v30, v51
    v_and_b32 v8, 0xffff0000, v15
    v_fma_f32 v51, v8, v31, v51
    v_lshlrev_b32 v8, 16, v16
    v_fma_f32 v51, v8, v32, v51
    v_and_b32 v8, 0xffff0000, v16
    v_fma_f32 v51, v8, v33, v51
    v_lshlrev_b32 v8, 16, v17
    v_fma_f32 v51, v8, v34, v51
    v_and_b32 v8, 0xffff0000, v17
    v_fma_f32 v51, v8, v35, v51
    v_lshlrev_b32 v8, 16, v18
    v_fma_f32 v51, v8, v36, v51
    v_and_b32 v8, 0xffff0000, v18
    v_fma_f32 v51, v8, v37, v51
    v_lshlrev_b32 v8, 16, v19
    v_fma_f32 v51, v8, v38, v51
    v_and_b32 v8, 0xffff0000, v19
    v_fma_f32 v51, v8, v39, v51
    v_cvt_pk_bf16_f32 v51, v51, v51
    v_and_b32 v51, 0xffff0000, v51
    v_mul_f32 v51, s35, v51
    v_cvt_pk_bf16_f32 v51, v51, v51
    v_and_b32 v51, 0xffff0000, v51
    v_cndmask_b32 v51, v9, v51, s[40:41]
    v_subrev_u32 v6, 4, v2
    v_cmp_le_u32 s[40:41], 4, v2
    s_nop 1
    v_cndmask_b32 v6, 0, v6, s[40:41]
    v_mul_u32_u24 v7, 3840, v6
    v_add_u32 v7, v7, v4
    v_add_u32 v7, 100663296, v7
    buffer_load_dword v10, v7, s[96:99], 0 offen offset:1280
    buffer_load_dword v11, v7, s[96:99], 0 offen offset:1284
    buffer_load_dword v12, v7, s[96:99], 0 offen offset:1288
    buffer_load_dword v13, v7, s[96:99], 0 offen offset:1292
    buffer_load_dword v14, v7, s[96:99], 0 offen offset:1296
    buffer_load_dword v15, v7, s[96:99], 0 offen offset:1300
    buffer_load_dword v16, v7, s[96:99], 0 offen offset:1304
    buffer_load_dword v17, v7, s[96:99], 0 offen offset:1308
    buffer_load_dword v18, v7, s[96:99], 0 offen offset:1312
    buffer_load_dword v19, v7, s[96:99], 0 offen offset:1316
    buffer_load_dword v80, v7, s[96:99], 0 offen offset:2560
    buffer_load_dword v81, v7, s[96:99], 0 offen offset:2564
    buffer_load_dword v82, v7, s[96:99], 0 offen offset:2568
    buffer_load_dword v83, v7, s[96:99], 0 offen offset:2572
    buffer_load_dword v84, v7, s[96:99], 0 offen offset:2576
    buffer_load_dword v85, v7, s[96:99], 0 offen offset:2580
    buffer_load_dword v86, v7, s[96:99], 0 offen offset:2584
    buffer_load_dword v87, v7, s[96:99], 0 offen offset:2588
    buffer_load_dword v88, v7, s[96:99], 0 offen offset:2592
    buffer_load_dword v89, v7, s[96:99], 0 offen offset:2596
    s_waitcnt vmcnt(10)
    v_mov_b32 v52, 0
    v_lshlrev_b32 v8, 16, v10
    v_fma_f32 v52, v8, v20, v52
    v_and_b32 v8, 0xffff0000, v10
    v_fma_f32 v52, v8, v21, v52
    v_lshlrev_b32 v8, 16, v11
    v_fma_f32 v52, v8, v22, v52
    v_and_b32 v8, 0xffff0000, v11
    v_fma_f32 v52, v8, v23, v52
    v_lshlrev_b32 v8, 16, v12
    v_fma_f32 v52, v8, v24, v52
    v_and_b32 v8, 0xffff0000, v12
    v_fma_f32 v52, v8, v25, v52
    v_lshlrev_b32 v8, 16, v13
    v_fma_f32 v52, v8, v26, v52
    v_and_b32 v8, 0xffff0000, v13
    v_fma_f32 v52, v8, v27, v52
    v_lshlrev_b32 v8, 16, v14
    v_fma_f32 v52, v8, v28, v52
    v_and_b32 v8, 0xffff0000, v14
    v_fma_f32 v52, v8, v29, v52
    v_lshlrev_b32 v8, 16, v15
    v_fma_f32 v52, v8, v30, v52
    v_and_b32 v8, 0xffff0000, v15
    v_fma_f32 v52, v8, v31, v52
    v_lshlrev_b32 v8, 16, v16
    v_fma_f32 v52, v8, v32, v52
    v_and_b32 v8, 0xffff0000, v16
    v_fma_f32 v52, v8, v33, v52
    v_lshlrev_b32 v8, 16, v17
    v_fma_f32 v52, v8, v34, v52
    v_and_b32 v8, 0xffff0000, v17
    v_fma_f32 v52, v8, v35, v52
    v_lshlrev_b32 v8, 16, v18
    v_fma_f32 v52, v8, v36, v52
    v_and_b32 v8, 0xffff0000, v18
    v_fma_f32 v52, v8, v37, v52
    v_lshlrev_b32 v8, 16, v19
    v_fma_f32 v52, v8, v38, v52
    v_and_b32 v8, 0xffff0000, v19
    v_fma_f32 v52, v8, v39, v52
    v_cvt_pk_bf16_f32 v52, v52, v52
    v_and_b32 v52, 0xffff0000, v52
    v_mul_f32 v52, s35, v52
    v_cvt_pk_bf16_f32 v52, v52, v52
    v_and_b32 v52, 0xffff0000, v52
    v_cndmask_b32 v52, v9, v52, s[40:41]
    v_subrev_u32 v6, 6, v2
    v_cmp_le_u32 s[40:41], 6, v2
    s_nop 1
    v_cndmask_b32 v6, 0, v6, s[40:41]
    v_mul_u32_u24 v7, 3840, v6
    v_add_u32 v7, v7, v4
    v_add_u32 v7, 100663296, v7
    buffer_load_dword v10, v7, s[96:99], 0 offen offset:1280
    buffer_load_dword v11, v7, s[96:99], 0 offen offset:1284
    buffer_load_dword v12, v7, s[96:99], 0 offen offset:1288
    buffer_load_dword v13, v7, s[96:99], 0 offen offset:1292
    buffer_load_dword v14, v7, s[96:99], 0 offen offset:1296
    buffer_load_dword v15, v7, s[96:99], 0 offen offset:1300
    buffer_load_dword v16, v7, s[96:99], 0 offen offset:1304
    buffer_load_dword v17, v7, s[96:99], 0 offen offset:1308
    buffer_load_dword v18, v7, s[96:99], 0 offen offset:1312
    buffer_load_dword v19, v7, s[96:99], 0 offen offset:1316
    buffer_load_dword v90, v7, s[96:99], 0 offen offset:2560
    buffer_load_dword v91, v7, s[96:99], 0 offen offset:2564
    buffer_load_dword v92, v7, s[96:99], 0 offen offset:2568
    buffer_load_dword v93, v7, s[96:99], 0 offen offset:2572
    buffer_load_dword v94, v7, s[96:99], 0 offen offset:2576
    buffer_load_dword v95, v7, s[96:99], 0 offen offset:2580
    buffer_load_dword v96, v7, s[96:99], 0 offen offset:2584
    buffer_load_dword v97, v7, s[96:99], 0 offen offset:2588
    buffer_load_dword v98, v7, s[96:99], 0 offen offset:2592
    buffer_load_dword v99, v7, s[96:99], 0 offen offset:2596
    s_waitcnt vmcnt(10)
    v_mov_b32 v53, 0
    v_lshlrev_b32 v8, 16, v10
    v_fma_f32 v53, v8, v20, v53
    v_and_b32 v8, 0xffff0000, v10
    v_fma_f32 v53, v8, v21, v53
    v_lshlrev_b32 v8, 16, v11
    v_fma_f32 v53, v8, v22, v53
    v_and_b32 v8, 0xffff0000, v11
    v_fma_f32 v53, v8, v23, v53
    v_lshlrev_b32 v8, 16, v12
    v_fma_f32 v53, v8, v24, v53
    v_and_b32 v8, 0xffff0000, v12
    v_fma_f32 v53, v8, v25, v53
    v_lshlrev_b32 v8, 16, v13
    v_fma_f32 v53, v8, v26, v53
    v_and_b32 v8, 0xffff0000, v13
    v_fma_f32 v53, v8, v27, v53
    v_lshlrev_b32 v8, 16, v14
    v_fma_f32 v53, v8, v28, v53
    v_and_b32 v8, 0xffff0000, v14
    v_fma_f32 v53, v8, v29, v53
    v_lshlrev_b32 v8, 16, v15
    v_fma_f32 v53, v8, v30, v53
    v_and_b32 v8, 0xffff0000, v15
    v_fma_f32 v53, v8, v31, v53
    v_lshlrev_b32 v8, 16, v16
    v_fma_f32 v53, v8, v32, v53
    v_and_b32 v8, 0xffff0000, v16
    v_fma_f32 v53, v8, v33, v53
    v_lshlrev_b32 v8, 16, v17
    v_fma_f32 v53, v8, v34, v53
    v_and_b32 v8, 0xffff0000, v17
    v_fma_f32 v53, v8, v35, v53
    v_lshlrev_b32 v8, 16, v18
    v_fma_f32 v53, v8, v36, v53
    v_and_b32 v8, 0xffff0000, v18
    v_fma_f32 v53, v8, v37, v53
    v_lshlrev_b32 v8, 16, v19
    v_fma_f32 v53, v8, v38, v53
    v_and_b32 v8, 0xffff0000, v19
    v_fma_f32 v53, v8, v39, v53
    v_cvt_pk_bf16_f32 v53, v53, v53
    v_and_b32 v53, 0xffff0000, v53
    v_mul_f32 v53, s35, v53
    v_cvt_pk_bf16_f32 v53, v53, v53
    v_and_b32 v53, 0xffff0000, v53
    v_cndmask_b32 v53, v9, v53, s[40:41]
    v_subrev_u32 v6, 8, v2
    v_cmp_le_u32 s[40:41], 8, v2
    s_nop 1
    v_cndmask_b32 v6, 0, v6, s[40:41]
    v_mul_u32_u24 v7, 3840, v6
    v_add_u32 v7, v7, v4
    v_add_u32 v7, 100663296, v7
    buffer_load_dword v10, v7, s[96:99], 0 offen offset:1280
    buffer_load_dword v11, v7, s[96:99], 0 offen offset:1284
    buffer_load_dword v12, v7, s[96:99], 0 offen offset:1288
    buffer_load_dword v13, v7, s[96:99], 0 offen offset:1292
    buffer_load_dword v14, v7, s[96:99], 0 offen offset:1296
    buffer_load_dword v15, v7, s[96:99], 0 offen offset:1300
    buffer_load_dword v16, v7, s[96:99], 0 offen offset:1304
    buffer_load_dword v17, v7, s[96:99], 0 offen offset:1308
    buffer_load_dword v18, v7, s[96:99], 0 offen offset:1312
    buffer_load_dword v19, v7, s[96:99], 0 offen offset:1316
    buffer_load_dword v100, v7, s[96:99], 0 offen offset:2560
    buffer_load_dword v101, v7, s[96:99], 0 offen offset:2564
    buffer_load_dword v102, v7, s[96:99], 0 offen offset:2568
    buffer_load_dword v103, v7, s[96:99], 0 offen offset:2572
    buffer_load_dword v104, v7, s[96:99], 0 offen offset:2576
    buffer_load_dword v105, v7, s[96:99], 0 offen offset:2580
    buffer_load_dword v106, v7, s[96:99], 0 offen offset:2584
    buffer_load_dword v107, v7, s[96:99], 0 offen offset:2588
    buffer_load_dword v108, v7, s[96:99], 0 offen offset:2592
    buffer_load_dword v109, v7, s[96:99], 0 offen offset:2596
    s_waitcnt vmcnt(10)
    v_mov_b32 v54, 0
    v_lshlrev_b32 v8, 16, v10
    v_fma_f32 v54, v8, v20, v54
    v_and_b32 v8, 0xffff0000, v10
    v_fma_f32 v54, v8, v21, v54
    v_lshlrev_b32 v8, 16, v11
    v_fma_f32 v54, v8, v22, v54
    v_and_b32 v8, 0xffff0000, v11
    v_fma_f32 v54, v8, v23, v54
    v_lshlrev_b32 v8, 16, v12
    v_fma_f32 v54, v8, v24, v54
    v_and_b32 v8, 0xffff0000, v12
    v_fma_f32 v54, v8, v25, v54
    v_lshlrev_b32 v8, 16, v13
    v_fma_f32 v54, v8, v26, v54
    v_and_b32 v8, 0xffff0000, v13
    v_fma_f32 v54, v8, v27, v54
    v_lshlrev_b32 v8, 16, v14
    v_fma_f32 v54, v8, v28, v54
    v_and_b32 v8, 0xffff0000, v14
    v_fma_f32 v54, v8, v29, v54
    v_lshlrev_b32 v8, 16, v15
    v_fma_f32 v54, v8, v30, v54
    v_and_b32 v8, 0xffff0000, v15
    v_fma_f32 v54, v8, v31, v54
    v_lshlrev_b32 v8, 16, v16
    v_fma_f32 v54, v8, v32, v54
    v_and_b32 v8, 0xffff0000, v16
    v_fma_f32 v54, v8, v33, v54
    v_lshlrev_b32 v8, 16, v17
    v_fma_f32 v54, v8, v34, v54
    v_and_b32 v8, 0xffff0000, v17
    v_fma_f32 v54, v8, v35, v54
    v_lshlrev_b32 v8, 16, v18
    v_fma_f32 v54, v8, v36, v54
    v_and_b32 v8, 0xffff0000, v18
    v_fma_f32 v54, v8, v37, v54
    v_lshlrev_b32 v8, 16, v19
    v_fma_f32 v54, v8, v38, v54
    v_and_b32 v8, 0xffff0000, v19
    v_fma_f32 v54, v8, v39, v54
    v_cvt_pk_bf16_f32 v54, v54, v54
    v_and_b32 v54, 0xffff0000, v54
    v_mul_f32 v54, s35, v54
    v_cvt_pk_bf16_f32 v54, v54, v54
    v_and_b32 v54, 0xffff0000, v54
    v_cndmask_b32 v54, v9, v54, s[40:41]
    v_subrev_u32 v6, 10, v2
    v_cmp_le_u32 s[40:41], 10, v2
    s_nop 1
    v_cndmask_b32 v6, 0, v6, s[40:41]
    v_mul_u32_u24 v7, 3840, v6
    v_add_u32 v7, v7, v4
    v_add_u32 v7, 100663296, v7
    buffer_load_dword v10, v7, s[96:99], 0 offen offset:1280
    buffer_load_dword v11, v7, s[96:99], 0 offen offset:1284
    buffer_load_dword v12, v7, s[96:99], 0 offen offset:1288
    buffer_load_dword v13, v7, s[96:99], 0 offen offset:1292
    buffer_load_dword v14, v7, s[96:99], 0 offen offset:1296
    buffer_load_dword v15, v7, s[96:99], 0 offen offset:1300
    buffer_load_dword v16, v7, s[96:99], 0 offen offset:1304
    buffer_load_dword v17, v7, s[96:99], 0 offen offset:1308
    buffer_load_dword v18, v7, s[96:99], 0 offen offset:1312
    buffer_load_dword v19, v7, s[96:99], 0 offen offset:1316
    buffer_load_dword v110, v7, s[96:99], 0 offen offset:2560
    buffer_load_dword v111, v7, s[96:99], 0 offen offset:2564
    buffer_load_dword v112, v7, s[96:99], 0 offen offset:2568
    buffer_load_dword v113, v7, s[96:99], 0 offen offset:2572
    buffer_load_dword v114, v7, s[96:99], 0 offen offset:2576
    buffer_load_dword v115, v7, s[96:99], 0 offen offset:2580
    buffer_load_dword v116, v7, s[96:99], 0 offen offset:2584
    buffer_load_dword v117, v7, s[96:99], 0 offen offset:2588
    buffer_load_dword v118, v7, s[96:99], 0 offen offset:2592
    buffer_load_dword v119, v7, s[96:99], 0 offen offset:2596
    s_waitcnt vmcnt(10)
    v_mov_b32 v55, 0
    v_lshlrev_b32 v8, 16, v10
    v_fma_f32 v55, v8, v20, v55
    v_and_b32 v8, 0xffff0000, v10
    v_fma_f32 v55, v8, v21, v55
    v_lshlrev_b32 v8, 16, v11
    v_fma_f32 v55, v8, v22, v55
    v_and_b32 v8, 0xffff0000, v11
    v_fma_f32 v55, v8, v23, v55
    v_lshlrev_b32 v8, 16, v12
    v_fma_f32 v55, v8, v24, v55
    v_and_b32 v8, 0xffff0000, v12
    v_fma_f32 v55, v8, v25, v55
    v_lshlrev_b32 v8, 16, v13
    v_fma_f32 v55, v8, v26, v55
    v_and_b32 v8, 0xffff0000, v13
    v_fma_f32 v55, v8, v27, v55
    v_lshlrev_b32 v8, 16, v14
    v_fma_f32 v55, v8, v28, v55
    v_and_b32 v8, 0xffff0000, v14
    v_fma_f32 v55, v8, v29, v55
    v_lshlrev_b32 v8, 16, v15
    v_fma_f32 v55, v8, v30, v55
    v_and_b32 v8, 0xffff0000, v15
    v_fma_f32 v55, v8, v31, v55
    v_lshlrev_b32 v8, 16, v16
    v_fma_f32 v55, v8, v32, v55
    v_and_b32 v8, 0xffff0000, v16
    v_fma_f32 v55, v8, v33, v55
    v_lshlrev_b32 v8, 16, v17
    v_fma_f32 v55, v8, v34, v55
    v_and_b32 v8, 0xffff0000, v17
    v_fma_f32 v55, v8, v35, v55
    v_lshlrev_b32 v8, 16, v18
    v_fma_f32 v55, v8, v36, v55
    v_and_b32 v8, 0xffff0000, v18
    v_fma_f32 v55, v8, v37, v55
    v_lshlrev_b32 v8, 16, v19
    v_fma_f32 v55, v8, v38, v55
    v_and_b32 v8, 0xffff0000, v19
    v_fma_f32 v55, v8, v39, v55
    v_cvt_pk_bf16_f32 v55, v55, v55
    v_and_b32 v55, 0xffff0000, v55
    v_mul_f32 v55, s35, v55
    v_cvt_pk_bf16_f32 v55, v55, v55
    v_and_b32 v55, 0xffff0000, v55
    v_cndmask_b32 v55, v9, v55, s[40:41]
    v_subrev_u32 v6, 12, v2
    v_cmp_le_u32 s[40:41], 12, v2
    s_nop 1
    v_cndmask_b32 v6, 0, v6, s[40:41]
    v_mul_u32_u24 v7, 3840, v6
    v_add_u32 v7, v7, v4
    v_add_u32 v7, 100663296, v7
    buffer_load_dword v10, v7, s[96:99], 0 offen offset:1280
    buffer_load_dword v11, v7, s[96:99], 0 offen offset:1284
    buffer_load_dword v12, v7, s[96:99], 0 offen offset:1288
    buffer_load_dword v13, v7, s[96:99], 0 offen offset:1292
    buffer_load_dword v14, v7, s[96:99], 0 offen offset:1296
    buffer_load_dword v15, v7, s[96:99], 0 offen offset:1300
    buffer_load_dword v16, v7, s[96:99], 0 offen offset:1304
    buffer_load_dword v17, v7, s[96:99], 0 offen offset:1308
    buffer_load_dword v18, v7, s[96:99], 0 offen offset:1312
    buffer_load_dword v19, v7, s[96:99], 0 offen offset:1316
    buffer_load_dword v120, v7, s[96:99], 0 offen offset:2560
    buffer_load_dword v121, v7, s[96:99], 0 offen offset:2564
    buffer_load_dword v122, v7, s[96:99], 0 offen offset:2568
    buffer_load_dword v123, v7, s[96:99], 0 offen offset:2572
    buffer_load_dword v124, v7, s[96:99], 0 offen offset:2576
    buffer_load_dword v125, v7, s[96:99], 0 offen offset:2580
    buffer_load_dword v126, v7, s[96:99], 0 offen offset:2584
    buffer_load_dword v127, v7, s[96:99], 0 offen offset:2588
    buffer_load_dword v128, v7, s[96:99], 0 offen offset:2592
    buffer_load_dword v129, v7, s[96:99], 0 offen offset:2596
    s_waitcnt vmcnt(10)
    v_mov_b32 v56, 0
    v_lshlrev_b32 v8, 16, v10
    v_fma_f32 v56, v8, v20, v56
    v_and_b32 v8, 0xffff0000, v10
    v_fma_f32 v56, v8, v21, v56
    v_lshlrev_b32 v8, 16, v11
    v_fma_f32 v56, v8, v22, v56
    v_and_b32 v8, 0xffff0000, v11
    v_fma_f32 v56, v8, v23, v56
    v_lshlrev_b32 v8, 16, v12
    v_fma_f32 v56, v8, v24, v56
    v_and_b32 v8, 0xffff0000, v12
    v_fma_f32 v56, v8, v25, v56
    v_lshlrev_b32 v8, 16, v13
    v_fma_f32 v56, v8, v26, v56
    v_and_b32 v8, 0xffff0000, v13
    v_fma_f32 v56, v8, v27, v56
    v_lshlrev_b32 v8, 16, v14
    v_fma_f32 v56, v8, v28, v56
    v_and_b32 v8, 0xffff0000, v14
    v_fma_f32 v56, v8, v29, v56
    v_lshlrev_b32 v8, 16, v15
    v_fma_f32 v56, v8, v30, v56
    v_and_b32 v8, 0xffff0000, v15
    v_fma_f32 v56, v8, v31, v56
    v_lshlrev_b32 v8, 16, v16
    v_fma_f32 v56, v8, v32, v56
    v_and_b32 v8, 0xffff0000, v16
    v_fma_f32 v56, v8, v33, v56
    v_lshlrev_b32 v8, 16, v17
    v_fma_f32 v56, v8, v34, v56
    v_and_b32 v8, 0xffff0000, v17
    v_fma_f32 v56, v8, v35, v56
    v_lshlrev_b32 v8, 16, v18
    v_fma_f32 v56, v8, v36, v56
    v_and_b32 v8, 0xffff0000, v18
    v_fma_f32 v56, v8, v37, v56
    v_lshlrev_b32 v8, 16, v19
    v_fma_f32 v56, v8, v38, v56
    v_and_b32 v8, 0xffff0000, v19
    v_fma_f32 v56, v8, v39, v56
    v_cvt_pk_bf16_f32 v56, v56, v56
    v_and_b32 v56, 0xffff0000, v56
    v_mul_f32 v56, s35, v56
    v_cvt_pk_bf16_f32 v56, v56, v56
    v_and_b32 v56, 0xffff0000, v56
    v_cndmask_b32 v56, v9, v56, s[40:41]
    v_subrev_u32 v6, 14, v2
    v_cmp_le_u32 s[40:41], 14, v2
    s_nop 1
    v_cndmask_b32 v6, 0, v6, s[40:41]
    v_mul_u32_u24 v7, 3840, v6
    v_add_u32 v7, v7, v4
    v_add_u32 v7, 100663296, v7
    buffer_load_dword v10, v7, s[96:99], 0 offen offset:1280
    buffer_load_dword v11, v7, s[96:99], 0 offen offset:1284
    buffer_load_dword v12, v7, s[96:99], 0 offen offset:1288
    buffer_load_dword v13, v7, s[96:99], 0 offen offset:1292
    buffer_load_dword v14, v7, s[96:99], 0 offen offset:1296
    buffer_load_dword v15, v7, s[96:99], 0 offen offset:1300
    buffer_load_dword v16, v7, s[96:99], 0 offen offset:1304
    buffer_load_dword v17, v7, s[96:99], 0 offen offset:1308
    buffer_load_dword v18, v7, s[96:99], 0 offen offset:1312
    buffer_load_dword v19, v7, s[96:99], 0 offen offset:1316
    buffer_load_dword v130, v7, s[96:99], 0 offen offset:2560
    buffer_load_dword v131, v7, s[96:99], 0 offen offset:2564
    buffer_load_dword v132, v7, s[96:99], 0 offen offset:2568
    buffer_load_dword v133, v7, s[96:99], 0 offen offset:2572
    buffer_load_dword v134, v7, s[96:99], 0 offen offset:2576
    buffer_load_dword v135, v7, s[96:99], 0 offen offset:2580
    buffer_load_dword v136, v7, s[96:99], 0 offen offset:2584
    buffer_load_dword v137, v7, s[96:99], 0 offen offset:2588
    buffer_load_dword v138, v7, s[96:99], 0 offen offset:2592
    buffer_load_dword v139, v7, s[96:99], 0 offen offset:2596
    s_waitcnt vmcnt(10)
    v_mov_b32 v57, 0
    v_lshlrev_b32 v8, 16, v10
    v_fma_f32 v57, v8, v20, v57
    v_and_b32 v8, 0xffff0000, v10
    v_fma_f32 v57, v8, v21, v57
    v_lshlrev_b32 v8, 16, v11
    v_fma_f32 v57, v8, v22, v57
    v_and_b32 v8, 0xffff0000, v11
    v_fma_f32 v57, v8, v23, v57
    v_lshlrev_b32 v8, 16, v12
    v_fma_f32 v57, v8, v24, v57
    v_and_b32 v8, 0xffff0000, v12
    v_fma_f32 v57, v8, v25, v57
    v_lshlrev_b32 v8, 16, v13
    v_fma_f32 v57, v8, v26, v57
    v_and_b32 v8, 0xffff0000, v13
    v_fma_f32 v57, v8, v27, v57
    v_lshlrev_b32 v8, 16, v14
    v_fma_f32 v57, v8, v28, v57
    v_and_b32 v8, 0xffff0000, v14
    v_fma_f32 v57, v8, v29, v57
    v_lshlrev_b32 v8, 16, v15
    v_fma_f32 v57, v8, v30, v57
    v_and_b32 v8, 0xffff0000, v15
    v_fma_f32 v57, v8, v31, v57
    v_lshlrev_b32 v8, 16, v16
    v_fma_f32 v57, v8, v32, v57
    v_and_b32 v8, 0xffff0000, v16
    v_fma_f32 v57, v8, v33, v57
    v_lshlrev_b32 v8, 16, v17
    v_fma_f32 v57, v8, v34, v57
    v_and_b32 v8, 0xffff0000, v17
    v_fma_f32 v57, v8, v35, v57
    v_lshlrev_b32 v8, 16, v18
    v_fma_f32 v57, v8, v36, v57
    v_and_b32 v8, 0xffff0000, v18
    v_fma_f32 v57, v8, v37, v57
    v_lshlrev_b32 v8, 16, v19
    v_fma_f32 v57, v8, v38, v57
    v_and_b32 v8, 0xffff0000, v19
    v_fma_f32 v57, v8, v39, v57
    v_cvt_pk_bf16_f32 v57, v57, v57
    v_and_b32 v57, 0xffff0000, v57
    v_mul_f32 v57, s35, v57
    v_cvt_pk_bf16_f32 v57, v57, v57
    v_and_b32 v57, 0xffff0000, v57
    v_cndmask_b32 v57, v9, v57, s[40:41]
    s_waitcnt vmcnt(0)
    v_mov_b32 v8, v50
    v_max_f32 v8, v8, v51
    v_max_f32 v8, v8, v52
    v_max_f32 v8, v8, v53
    v_max_f32 v8, v8, v54
    v_max_f32 v8, v8, v55
    v_max_f32 v8, v8, v56
    v_max_f32 v8, v8, v57
    s_mov_b32 s35, 0x3fb8aa3b
    v_mov_b32 v9, 0
    v_sub_f32 v50, v50, v8
    v_mul_f32 v50, s35, v50
    v_exp_f32 v50, v50
    s_nop 0
    v_add_f32 v9, v9, v50
    v_sub_f32 v51, v51, v8
    v_mul_f32 v51, s35, v51
    v_exp_f32 v51, v51
    s_nop 0
    v_add_f32 v9, v9, v51
    v_sub_f32 v52, v52, v8
    v_mul_f32 v52, s35, v52
    v_exp_f32 v52, v52
    s_nop 0
    v_add_f32 v9, v9, v52
    v_sub_f32 v53, v53, v8
    v_mul_f32 v53, s35, v53
    v_exp_f32 v53, v53
    s_nop 0
    v_add_f32 v9, v9, v53
    v_sub_f32 v54, v54, v8
    v_mul_f32 v54, s35, v54
    v_exp_f32 v54, v54
    s_nop 0
    v_add_f32 v9, v9, v54
    v_sub_f32 v55, v55, v8
    v_mul_f32 v55, s35, v55
    v_exp_f32 v55, v55
    s_nop 0
    v_add_f32 v9, v9, v55
    v_sub_f32 v56, v56, v8
    v_mul_f32 v56, s35, v56
    v_exp_f32 v56, v56
    s_nop 0
    v_add_f32 v9, v9, v56
    v_sub_f32 v57, v57, v8
    v_mul_f32 v57, s35, v57
    v_exp_f32 v57, v57
    s_nop 0
    v_add_f32 v9, v9, v57
    v_rcp_f32 v9, v9
    s_nop 0
    v_mul_f32 v50, v50, v9
    v_cvt_pk_bf16_f32 v50, v50, v50
    v_and_b32 v50, 0xffff0000, v50
    v_mul_f32 v51, v51, v9
    v_cvt_pk_bf16_f32 v51, v51, v51
    v_and_b32 v51, 0xffff0000, v51
    v_mul_f32 v52, v52, v9
    v_cvt_pk_bf16_f32 v52, v52, v52
    v_and_b32 v52, 0xffff0000, v52
    v_mul_f32 v53, v53, v9
    v_cvt_pk_bf16_f32 v53, v53, v53
    v_and_b32 v53, 0xffff0000, v53
    v_mul_f32 v54, v54, v9
    v_cvt_pk_bf16_f32 v54, v54, v54
    v_and_b32 v54, 0xffff0000, v54
    v_mul_f32 v55, v55, v9
    v_cvt_pk_bf16_f32 v55, v55, v55
    v_and_b32 v55, 0xffff0000, v55
    v_mul_f32 v56, v56, v9
    v_cvt_pk_bf16_f32 v56, v56, v56
    v_and_b32 v56, 0xffff0000, v56
    v_mul_f32 v57, v57, v9
    v_cvt_pk_bf16_f32 v57, v57, v57
    v_and_b32 v57, 0xffff0000, v57
    v_mul_u32_u24 v5, 1280, v2
    v_add_u32 v5, v5, v4
    v_add_u32 v5, 138412032, v5
    v_mov_b32 v10, 0
    v_mov_b32 v11, 0
    v_lshlrev_b32 v8, 16, v60
    v_fma_f32 v10, v8, v50, v10
    v_and_b32 v8, 0xffff0000, v60
    v_fma_f32 v11, v8, v50, v11
    v_lshlrev_b32 v8, 16, v70
    v_fma_f32 v10, v8, v51, v10
    v_and_b32 v8, 0xffff0000, v70
    v_fma_f32 v11, v8, v51, v11
    v_lshlrev_b32 v8, 16, v80
    v_fma_f32 v10, v8, v52, v10
    v_and_b32 v8, 0xffff0000, v80
    v_fma_f32 v11, v8, v52, v11
    v_lshlrev_b32 v8, 16, v90
    v_fma_f32 v10, v8, v53, v10
    v_and_b32 v8, 0xffff0000, v90
    v_fma_f32 v11, v8, v53, v11
    v_lshlrev_b32 v8, 16, v100
    v_fma_f32 v10, v8, v54, v10
    v_and_b32 v8, 0xffff0000, v100
    v_fma_f32 v11, v8, v54, v11
    v_lshlrev_b32 v8, 16, v110
    v_fma_f32 v10, v8, v55, v10
    v_and_b32 v8, 0xffff0000, v110
    v_fma_f32 v11, v8, v55, v11
    v_lshlrev_b32 v8, 16, v120
    v_fma_f32 v10, v8, v56, v10
    v_and_b32 v8, 0xffff0000, v120
    v_fma_f32 v11, v8, v56, v11
    v_lshlrev_b32 v8, 16, v130
    v_fma_f32 v10, v8, v57, v10
    v_and_b32 v8, 0xffff0000, v130
    v_fma_f32 v11, v8, v57, v11
    v_cvt_pk_bf16_f32 v12, v10, v11
    buffer_store_dword v12, v5, s[96:99], 0 offen offset:0 sc1
    v_mov_b32 v10, 0
    v_mov_b32 v11, 0
    v_lshlrev_b32 v8, 16, v61
    v_fma_f32 v10, v8, v50, v10
    v_and_b32 v8, 0xffff0000, v61
    v_fma_f32 v11, v8, v50, v11
    v_lshlrev_b32 v8, 16, v71
    v_fma_f32 v10, v8, v51, v10
    v_and_b32 v8, 0xffff0000, v71
    v_fma_f32 v11, v8, v51, v11
    v_lshlrev_b32 v8, 16, v81
    v_fma_f32 v10, v8, v52, v10
    v_and_b32 v8, 0xffff0000, v81
    v_fma_f32 v11, v8, v52, v11
    v_lshlrev_b32 v8, 16, v91
    v_fma_f32 v10, v8, v53, v10
    v_and_b32 v8, 0xffff0000, v91
    v_fma_f32 v11, v8, v53, v11
    v_lshlrev_b32 v8, 16, v101
    v_fma_f32 v10, v8, v54, v10
    v_and_b32 v8, 0xffff0000, v101
    v_fma_f32 v11, v8, v54, v11
    v_lshlrev_b32 v8, 16, v111
    v_fma_f32 v10, v8, v55, v10
    v_and_b32 v8, 0xffff0000, v111
    v_fma_f32 v11, v8, v55, v11
    v_lshlrev_b32 v8, 16, v121
    v_fma_f32 v10, v8, v56, v10
    v_and_b32 v8, 0xffff0000, v121
    v_fma_f32 v11, v8, v56, v11
    v_lshlrev_b32 v8, 16, v131
    v_fma_f32 v10, v8, v57, v10
    v_and_b32 v8, 0xffff0000, v131
    v_fma_f32 v11, v8, v57, v11
    v_cvt_pk_bf16_f32 v12, v10, v11
    buffer_store_dword v12, v5, s[96:99], 0 offen offset:4 sc1
    v_mov_b32 v10, 0
    v_mov_b32 v11, 0
    v_lshlrev_b32 v8, 16, v62
    v_fma_f32 v10, v8, v50, v10
    v_and_b32 v8, 0xffff0000, v62
    v_fma_f32 v11, v8, v50, v11
    v_lshlrev_b32 v8, 16, v72
    v_fma_f32 v10, v8, v51, v10
    v_and_b32 v8, 0xffff0000, v72
    v_fma_f32 v11, v8, v51, v11
    v_lshlrev_b32 v8, 16, v82
    v_fma_f32 v10, v8, v52, v10
    v_and_b32 v8, 0xffff0000, v82
    v_fma_f32 v11, v8, v52, v11
    v_lshlrev_b32 v8, 16, v92
    v_fma_f32 v10, v8, v53, v10
    v_and_b32 v8, 0xffff0000, v92
    v_fma_f32 v11, v8, v53, v11
    v_lshlrev_b32 v8, 16, v102
    v_fma_f32 v10, v8, v54, v10
    v_and_b32 v8, 0xffff0000, v102
    v_fma_f32 v11, v8, v54, v11
    v_lshlrev_b32 v8, 16, v112
    v_fma_f32 v10, v8, v55, v10
    v_and_b32 v8, 0xffff0000, v112
    v_fma_f32 v11, v8, v55, v11
    v_lshlrev_b32 v8, 16, v122
    v_fma_f32 v10, v8, v56, v10
    v_and_b32 v8, 0xffff0000, v122
    v_fma_f32 v11, v8, v56, v11
    v_lshlrev_b32 v8, 16, v132
    v_fma_f32 v10, v8, v57, v10
    v_and_b32 v8, 0xffff0000, v132
    v_fma_f32 v11, v8, v57, v11
    v_cvt_pk_bf16_f32 v12, v10, v11
    buffer_store_dword v12, v5, s[96:99], 0 offen offset:8 sc1
    v_mov_b32 v10, 0
    v_mov_b32 v11, 0
    v_lshlrev_b32 v8, 16, v63
    v_fma_f32 v10, v8, v50, v10
    v_and_b32 v8, 0xffff0000, v63
    v_fma_f32 v11, v8, v50, v11
    v_lshlrev_b32 v8, 16, v73
    v_fma_f32 v10, v8, v51, v10
    v_and_b32 v8, 0xffff0000, v73
    v_fma_f32 v11, v8, v51, v11
    v_lshlrev_b32 v8, 16, v83
    v_fma_f32 v10, v8, v52, v10
    v_and_b32 v8, 0xffff0000, v83
    v_fma_f32 v11, v8, v52, v11
    v_lshlrev_b32 v8, 16, v93
    v_fma_f32 v10, v8, v53, v10
    v_and_b32 v8, 0xffff0000, v93
    v_fma_f32 v11, v8, v53, v11
    v_lshlrev_b32 v8, 16, v103
    v_fma_f32 v10, v8, v54, v10
    v_and_b32 v8, 0xffff0000, v103
    v_fma_f32 v11, v8, v54, v11
    v_lshlrev_b32 v8, 16, v113
    v_fma_f32 v10, v8, v55, v10
    v_and_b32 v8, 0xffff0000, v113
    v_fma_f32 v11, v8, v55, v11
    v_lshlrev_b32 v8, 16, v123
    v_fma_f32 v10, v8, v56, v10
    v_and_b32 v8, 0xffff0000, v123
    v_fma_f32 v11, v8, v56, v11
    v_lshlrev_b32 v8, 16, v133
    v_fma_f32 v10, v8, v57, v10
    v_and_b32 v8, 0xffff0000, v133
    v_fma_f32 v11, v8, v57, v11
    v_cvt_pk_bf16_f32 v12, v10, v11
    buffer_store_dword v12, v5, s[96:99], 0 offen offset:12 sc1
    v_mov_b32 v10, 0
    v_mov_b32 v11, 0
    v_lshlrev_b32 v8, 16, v64
    v_fma_f32 v10, v8, v50, v10
    v_and_b32 v8, 0xffff0000, v64
    v_fma_f32 v11, v8, v50, v11
    v_lshlrev_b32 v8, 16, v74
    v_fma_f32 v10, v8, v51, v10
    v_and_b32 v8, 0xffff0000, v74
    v_fma_f32 v11, v8, v51, v11
    v_lshlrev_b32 v8, 16, v84
    v_fma_f32 v10, v8, v52, v10
    v_and_b32 v8, 0xffff0000, v84
    v_fma_f32 v11, v8, v52, v11
    v_lshlrev_b32 v8, 16, v94
    v_fma_f32 v10, v8, v53, v10
    v_and_b32 v8, 0xffff0000, v94
    v_fma_f32 v11, v8, v53, v11
    v_lshlrev_b32 v8, 16, v104
    v_fma_f32 v10, v8, v54, v10
    v_and_b32 v8, 0xffff0000, v104
    v_fma_f32 v11, v8, v54, v11
    v_lshlrev_b32 v8, 16, v114
    v_fma_f32 v10, v8, v55, v10
    v_and_b32 v8, 0xffff0000, v114
    v_fma_f32 v11, v8, v55, v11
    v_lshlrev_b32 v8, 16, v124
    v_fma_f32 v10, v8, v56, v10
    v_and_b32 v8, 0xffff0000, v124
    v_fma_f32 v11, v8, v56, v11
    v_lshlrev_b32 v8, 16, v134
    v_fma_f32 v10, v8, v57, v10
    v_and_b32 v8, 0xffff0000, v134
    v_fma_f32 v11, v8, v57, v11
    v_cvt_pk_bf16_f32 v12, v10, v11
    buffer_store_dword v12, v5, s[96:99], 0 offen offset:16 sc1
    v_mov_b32 v10, 0
    v_mov_b32 v11, 0
    v_lshlrev_b32 v8, 16, v65
    v_fma_f32 v10, v8, v50, v10
    v_and_b32 v8, 0xffff0000, v65
    v_fma_f32 v11, v8, v50, v11
    v_lshlrev_b32 v8, 16, v75
    v_fma_f32 v10, v8, v51, v10
    v_and_b32 v8, 0xffff0000, v75
    v_fma_f32 v11, v8, v51, v11
    v_lshlrev_b32 v8, 16, v85
    v_fma_f32 v10, v8, v52, v10
    v_and_b32 v8, 0xffff0000, v85
    v_fma_f32 v11, v8, v52, v11
    v_lshlrev_b32 v8, 16, v95
    v_fma_f32 v10, v8, v53, v10
    v_and_b32 v8, 0xffff0000, v95
    v_fma_f32 v11, v8, v53, v11
    v_lshlrev_b32 v8, 16, v105
    v_fma_f32 v10, v8, v54, v10
    v_and_b32 v8, 0xffff0000, v105
    v_fma_f32 v11, v8, v54, v11
    v_lshlrev_b32 v8, 16, v115
    v_fma_f32 v10, v8, v55, v10
    v_and_b32 v8, 0xffff0000, v115
    v_fma_f32 v11, v8, v55, v11
    v_lshlrev_b32 v8, 16, v125
    v_fma_f32 v10, v8, v56, v10
    v_and_b32 v8, 0xffff0000, v125
    v_fma_f32 v11, v8, v56, v11
    v_lshlrev_b32 v8, 16, v135
    v_fma_f32 v10, v8, v57, v10
    v_and_b32 v8, 0xffff0000, v135
    v_fma_f32 v11, v8, v57, v11
    v_cvt_pk_bf16_f32 v12, v10, v11
    buffer_store_dword v12, v5, s[96:99], 0 offen offset:20 sc1
    v_mov_b32 v10, 0
    v_mov_b32 v11, 0
    v_lshlrev_b32 v8, 16, v66
    v_fma_f32 v10, v8, v50, v10
    v_and_b32 v8, 0xffff0000, v66
    v_fma_f32 v11, v8, v50, v11
    v_lshlrev_b32 v8, 16, v76
    v_fma_f32 v10, v8, v51, v10
    v_and_b32 v8, 0xffff0000, v76
    v_fma_f32 v11, v8, v51, v11
    v_lshlrev_b32 v8, 16, v86
    v_fma_f32 v10, v8, v52, v10
    v_and_b32 v8, 0xffff0000, v86
    v_fma_f32 v11, v8, v52, v11
    v_lshlrev_b32 v8, 16, v96
    v_fma_f32 v10, v8, v53, v10
    v_and_b32 v8, 0xffff0000, v96
    v_fma_f32 v11, v8, v53, v11
    v_lshlrev_b32 v8, 16, v106
    v_fma_f32 v10, v8, v54, v10
    v_and_b32 v8, 0xffff0000, v106
    v_fma_f32 v11, v8, v54, v11
    v_lshlrev_b32 v8, 16, v116
    v_fma_f32 v10, v8, v55, v10
    v_and_b32 v8, 0xffff0000, v116
    v_fma_f32 v11, v8, v55, v11
    v_lshlrev_b32 v8, 16, v126
    v_fma_f32 v10, v8, v56, v10
    v_and_b32 v8, 0xffff0000, v126
    v_fma_f32 v11, v8, v56, v11
    v_lshlrev_b32 v8, 16, v136
    v_fma_f32 v10, v8, v57, v10
    v_and_b32 v8, 0xffff0000, v136
    v_fma_f32 v11, v8, v57, v11
    v_cvt_pk_bf16_f32 v12, v10, v11
    buffer_store_dword v12, v5, s[96:99], 0 offen offset:24 sc1
    v_mov_b32 v10, 0
    v_mov_b32 v11, 0
    v_lshlrev_b32 v8, 16, v67
    v_fma_f32 v10, v8, v50, v10
    v_and_b32 v8, 0xffff0000, v67
    v_fma_f32 v11, v8, v50, v11
    v_lshlrev_b32 v8, 16, v77
    v_fma_f32 v10, v8, v51, v10
    v_and_b32 v8, 0xffff0000, v77
    v_fma_f32 v11, v8, v51, v11
    v_lshlrev_b32 v8, 16, v87
    v_fma_f32 v10, v8, v52, v10
    v_and_b32 v8, 0xffff0000, v87
    v_fma_f32 v11, v8, v52, v11
    v_lshlrev_b32 v8, 16, v97
    v_fma_f32 v10, v8, v53, v10
    v_and_b32 v8, 0xffff0000, v97
    v_fma_f32 v11, v8, v53, v11
    v_lshlrev_b32 v8, 16, v107
    v_fma_f32 v10, v8, v54, v10
    v_and_b32 v8, 0xffff0000, v107
    v_fma_f32 v11, v8, v54, v11
    v_lshlrev_b32 v8, 16, v117
    v_fma_f32 v10, v8, v55, v10
    v_and_b32 v8, 0xffff0000, v117
    v_fma_f32 v11, v8, v55, v11
    v_lshlrev_b32 v8, 16, v127
    v_fma_f32 v10, v8, v56, v10
    v_and_b32 v8, 0xffff0000, v127
    v_fma_f32 v11, v8, v56, v11
    v_lshlrev_b32 v8, 16, v137
    v_fma_f32 v10, v8, v57, v10
    v_and_b32 v8, 0xffff0000, v137
    v_fma_f32 v11, v8, v57, v11
    v_cvt_pk_bf16_f32 v12, v10, v11
    buffer_store_dword v12, v5, s[96:99], 0 offen offset:28 sc1
    v_mov_b32 v10, 0
    v_mov_b32 v11, 0
    v_lshlrev_b32 v8, 16, v68
    v_fma_f32 v10, v8, v50, v10
    v_and_b32 v8, 0xffff0000, v68
    v_fma_f32 v11, v8, v50, v11
    v_lshlrev_b32 v8, 16, v78
    v_fma_f32 v10, v8, v51, v10
    v_and_b32 v8, 0xffff0000, v78
    v_fma_f32 v11, v8, v51, v11
    v_lshlrev_b32 v8, 16, v88
    v_fma_f32 v10, v8, v52, v10
    v_and_b32 v8, 0xffff0000, v88
    v_fma_f32 v11, v8, v52, v11
    v_lshlrev_b32 v8, 16, v98
    v_fma_f32 v10, v8, v53, v10
    v_and_b32 v8, 0xffff0000, v98
    v_fma_f32 v11, v8, v53, v11
    v_lshlrev_b32 v8, 16, v108
    v_fma_f32 v10, v8, v54, v10
    v_and_b32 v8, 0xffff0000, v108
    v_fma_f32 v11, v8, v54, v11
    v_lshlrev_b32 v8, 16, v118
    v_fma_f32 v10, v8, v55, v10
    v_and_b32 v8, 0xffff0000, v118
    v_fma_f32 v11, v8, v55, v11
    v_lshlrev_b32 v8, 16, v128
    v_fma_f32 v10, v8, v56, v10
    v_and_b32 v8, 0xffff0000, v128
    v_fma_f32 v11, v8, v56, v11
    v_lshlrev_b32 v8, 16, v138
    v_fma_f32 v10, v8, v57, v10
    v_and_b32 v8, 0xffff0000, v138
    v_fma_f32 v11, v8, v57, v11
    v_cvt_pk_bf16_f32 v12, v10, v11
    buffer_store_dword v12, v5, s[96:99], 0 offen offset:32 sc1
    v_mov_b32 v10, 0
    v_mov_b32 v11, 0
    v_lshlrev_b32 v8, 16, v69
    v_fma_f32 v10, v8, v50, v10
    v_and_b32 v8, 0xffff0000, v69
    v_fma_f32 v11, v8, v50, v11
    v_lshlrev_b32 v8, 16, v79
    v_fma_f32 v10, v8, v51, v10
    v_and_b32 v8, 0xffff0000, v79
    v_fma_f32 v11, v8, v51, v11
    v_lshlrev_b32 v8, 16, v89
    v_fma_f32 v10, v8, v52, v10
    v_and_b32 v8, 0xffff0000, v89
    v_fma_f32 v11, v8, v52, v11
    v_lshlrev_b32 v8, 16, v99
    v_fma_f32 v10, v8, v53, v10
    v_and_b32 v8, 0xffff0000, v99
    v_fma_f32 v11, v8, v53, v11
    v_lshlrev_b32 v8, 16, v109
    v_fma_f32 v10, v8, v54, v10
    v_and_b32 v8, 0xffff0000, v109
    v_fma_f32 v11, v8, v54, v11
    v_lshlrev_b32 v8, 16, v119
    v_fma_f32 v10, v8, v55, v10
    v_and_b32 v8, 0xffff0000, v119
    v_fma_f32 v11, v8, v55, v11
    v_lshlrev_b32 v8, 16, v129
    v_fma_f32 v10, v8, v56, v10
    v_and_b32 v8, 0xffff0000, v129
    v_fma_f32 v11, v8, v56, v11
    v_lshlrev_b32 v8, 16, v139
    v_fma_f32 v10, v8, v57, v10
    v_and_b32 v8, 0xffff0000, v139
    v_fma_f32 v11, v8, v57, v11
    v_cvt_pk_bf16_f32 v12, v10, v11
    buffer_store_dword v12, v5, s[96:99], 0 offen offset:36 sc1
att_end:
    s_waitcnt vmcnt(0)
    s_barrier
    s_cmp_lg_u32 s7, 0
    s_cbranch_scc1 sg7_d
    v_mov_b32 v250, 1
    s_mov_b64 exec, 1
    buffer_atomic_add v250, off, s[96:99], s36 sc1
sg7_d:
    s_endpgm
fine2:
    s_load_dwordx2 s[12:13], s[0:1], 80
    s_waitcnt lgkmcnt(0)
    s_mov_b32 s14, 5242880
    s_mov_b32 s15, 0x00020000
    s_sub_u32 s5, s5, 8
    s_mov_b32 s19, 0
    v_and_b32 v3, 15, v2
    v_lshrrev_b32 v4, 4, v2
    v_lshlrev_b32 v5, 13, v3
    v_lshl_add_u32 v5, v4, 4, v5
    v_add_u32 v6, 0x20000, v5
    s_lshl_b32 s16, s5, 18
    s_lshl_b32 s17, s7, 11
    s_add_u32 s16, s16, s17
    s_add_u32 s16, s16, 16777216
    s_lshl_b32 s18, s4, 18
    s_add_u32 s18, s18, s17
    s_add_u32 s18, s18, 117440512
    s_lshl_b32 s17, s19, 17
    s_add_u32 s18, s18, s17
    buffer_load_dwordx4 a[0:3], v5, s[96:99], s16 offen offset:0
    buffer_load_dwordx4 a[4:7], v6, s[96:99], s16 offen offset:0
    buffer_load_dwordx4 a[8:11], v5, s[96:99], s16 offen offset:64
    buffer_load_dwordx4 a[12:15], v6, s[96:99], s16 offen offset:64
    buffer_load_dwordx4 a[16:19], v5, s[96:99], s16 offen offset:128
    buffer_load_dwordx4 a[20:23], v6, s[96:99], s16 offen offset:128
    buffer_load_dwordx4 a[24:27], v5, s[96:99], s16 offen offset:192
    buffer_load_dwordx4 a[28:31], v6, s[96:99], s16 offen offset:192
    buffer_load_dwordx4 a[32:35], v5, s[96:99], s16 offen offset:256
    buffer_load_dwordx4 a[36:39], v6, s[96:99], s16 offen offset:256
    buffer_load_dwordx4 a[40:43], v5, s[96:99], s16 offen offset:320
    buffer_load_dwordx4 a[44:47], v6, s[96:99], s16 offen offset:320
    buffer_load_dwordx4 a[48:51], v5, s[96:99], s16 offen offset:384
    buffer_load_dwordx4 a[52:55], v6, s[96:99], s16 offen offset:384
    buffer_load_dwordx4 a[56:59], v5, s[96:99], s16 offen offset:448
    buffer_load_dwordx4 a[60:63], v6, s[96:99], s16 offen offset:448
    buffer_load_dwordx4 a[64:67], v5, s[96:99], s16 offen offset:512
    buffer_load_dwordx4 a[68:71], v6, s[96:99], s16 offen offset:512
    buffer_load_dwordx4 a[72:75], v5, s[96:99], s16 offen offset:576
    buffer_load_dwordx4 a[76:79], v6, s[96:99], s16 offen offset:576
    buffer_load_dwordx4 a[80:83], v5, s[96:99], s16 offen offset:640
    buffer_load_dwordx4 a[84:87], v6, s[96:99], s16 offen offset:640
    buffer_load_dwordx4 a[88:91], v5, s[96:99], s16 offen offset:704
    buffer_load_dwordx4 a[92:95], v6, s[96:99], s16 offen offset:704
    buffer_load_dwordx4 a[96:99], v5, s[96:99], s16 offen offset:768
    buffer_load_dwordx4 a[100:103], v6, s[96:99], s16 offen offset:768
    buffer_load_dwordx4 a[104:107], v5, s[96:99], s16 offen offset:832
    buffer_load_dwordx4 a[108:111], v6, s[96:99], s16 offen offset:832
    buffer_load_dwordx4 a[112:115], v5, s[96:99], s16 offen offset:896
    buffer_load_dwordx4 a[116:119], v6, s[96:99], s16 offen offset:896
    buffer_load_dwordx4 a[120:123], v5, s[96:99], s16 offen offset:960
    buffer_load_dwordx4 a[124:127], v6, s[96:99], s16 offen offset:960
    buffer_load_dwordx4 a[128:131], v5, s[96:99], s16 offen offset:1024
    buffer_load_dwordx4 a[132:135], v6, s[96:99], s16 offen offset:1024
    buffer_load_dwordx4 a[136:139], v5, s[96:99], s16 offen offset:1088
    buffer_load_dwordx4 a[140:143], v6, s[96:99], s16 offen offset:1088
    buffer_load_dwordx4 a[144:147], v5, s[96:99], s16 offen offset:1152
    buffer_load_dwordx4 a[148:151], v6, s[96:99], s16 offen offset:1152
    buffer_load_dwordx4 a[152:155], v5, s[96:99], s16 offen offset:1216
    buffer_load_dwordx4 a[156:159], v6, s[96:99], s16 offen offset:1216
    buffer_load_dwordx4 a[160:163], v5, s[96:99], s16 offen offset:1280
    buffer_load_dwordx4 a[164:167], v6, s[96:99], s16 offen offset:1280
    buffer_load_dwordx4 a[168:171], v5, s[96:99], s16 offen offset:1344
    buffer_load_dwordx4 a[172:175], v6, s[96:99], s16 offen offset:1344
    buffer_load_dwordx4 a[176:179], v5, s[96:99], s16 offen offset:1408
    buffer_load_dwordx4 a[180:183], v6, s[96:99], s16 offen offset:1408
    buffer_load_dwordx4 a[184:187], v5, s[96:99], s16 offen offset:1472
    buffer_load_dwordx4 a[188:191], v6, s[96:99], s16 offen offset:1472
    buffer_load_dwordx4 a[192:195], v5, s[96:99], s16 offen offset:1536
    buffer_load_dwordx4 a[196:199], v6, s[96:99], s16 offen offset:1536
    buffer_load_dwordx4 a[200:203], v5, s[96:99], s16 offen offset:1600
    buffer_load_dwordx4 a[204:207], v6, s[96:99], s16 offen offset:1600
    buffer_load_dwordx4 a[208:211], v5, s[96:99], s16 offen offset:1664
    buffer_load_dwordx4 a[212:215], v6, s[96:99], s16 offen offset:1664
    buffer_load_dwordx4 a[216:219], v5, s[96:99], s16 offen offset:1728
    buffer_load_dwordx4 a[220:223], v6, s[96:99], s16 offen offset:1728
    buffer_load_dwordx4 a[224:227], v5, s[96:99], s16 offen offset:1792
    buffer_load_dwordx4 a[228:231], v6, s[96:99], s16 offen offset:1792
    buffer_load_dwordx4 a[232:235], v5, s[96:99], s16 offen offset:1856
    buffer_load_dwordx4 a[236:239], v6, s[96:99], s16 offen offset:1856
    buffer_load_dwordx4 a[240:243], v5, s[96:99], s16 offen offset:1920
    buffer_load_dwordx4 a[244:247], v6, s[96:99], s16 offen offset:1920
    buffer_load_dwordx4 a[248:251], v5, s[96:99], s16 offen offset:1984
    buffer_load_dwordx4 a[252:255], v6, s[96:99], s16 offen offset:1984
    s_lshl_b32 s3, s4, 8
    s_add_u32 s3, s3, 152584192
    v_mov_b32 v8, s3
    v_mov_b32 v9, 8
    s_cmp_lg_u32 s7, 0
    s_cbranch_scc1 wt8_d
    s_mov_b32 s37, 0
wt8_l:
    buffer_load_dword v10, v8, s[96:99], 0 offen sc1
    s_waitcnt vmcnt(0)
    v_cmp_gt_u32 vcc, v9, v10
    s_nop 1
    s_cbranch_vccz wt8_d
    s_add_u32 s37, s37, 1
    s_cmp_gt_u32 s37, 0x20000
    s_cbranch_scc1 wt8_d
    s_sleep 16
    s_branch wt8_l
wt8_d:
    s_barrier
    buffer_load_dwordx4 v[128:131], v5, s[96:99], s18 offen offset:0
    buffer_load_dwordx4 v[132:135], v6, s[96:99], s18 offen offset:0
    buffer_load_dwordx4 v[136:139], v5, s[96:99], s18 offen offset:64
    buffer_load_dwordx4 v[140:143], v6, s[96:99], s18 offen offset:64
    buffer_load_dwordx4 v[144:147], v5, s[96:99], s18 offen offset:128
    buffer_load_dwordx4 v[148:151], v6, s[96:99], s18 offen offset:128
    buffer_load_dwordx4 v[152:155], v5, s[96:99], s18 offen offset:192
    buffer_load_dwordx4 v[156:159], v6, s[96:99], s18 offen offset:192
    buffer_load_dwordx4 v[160:163], v5, s[96:99], s18 offen offset:256
    buffer_load_dwordx4 v[164:167], v6, s[96:99], s18 offen offset:256
    buffer_load_dwordx4 v[168:171], v5, s[96:99], s18 offen offset:320
    buffer_load_dwordx4 v[172:175], v6, s[96:99], s18 offen offset:320
    buffer_load_dwordx4 v[176:179], v5, s[96:99], s18 offen offset:384
    buffer_load_dwordx4 v[180:183], v6, s[96:99], s18 offen offset:384
    buffer_load_dwordx4 v[184:187], v5, s[96:99], s18 offen offset:448
    buffer_load_dwordx4 v[188:191], v6, s[96:99], s18 offen offset:448
    buffer_load_dwordx4 v[192:195], v5, s[96:99], s18 offen offset:512
    buffer_load_dwordx4 v[196:199], v6, s[96:99], s18 offen offset:512
    buffer_load_dwordx4 v[200:203], v5, s[96:99], s18 offen offset:576
    buffer_load_dwordx4 v[204:207], v6, s[96:99], s18 offen offset:576
    buffer_load_dwordx4 v[208:211], v5, s[96:99], s18 offen offset:640
    buffer_load_dwordx4 v[212:215], v6, s[96:99], s18 offen offset:640
    buffer_load_dwordx4 v[216:219], v5, s[96:99], s18 offen offset:704
    buffer_load_dwordx4 v[220:223], v6, s[96:99], s18 offen offset:704
    buffer_load_dwordx4 v[224:227], v5, s[96:99], s18 offen offset:768
    buffer_load_dwordx4 v[228:231], v6, s[96:99], s18 offen offset:768
    buffer_load_dwordx4 v[232:235], v5, s[96:99], s18 offen offset:832
    buffer_load_dwordx4 v[236:239], v6, s[96:99], s18 offen offset:832
    buffer_load_dwordx4 v[240:243], v5, s[96:99], s18 offen offset:896
    buffer_load_dwordx4 v[244:247], v6, s[96:99], s18 offen offset:896
    buffer_load_dwordx4 v[248:251], v5, s[96:99], s18 offen offset:960
    buffer_load_dwordx4 v[252:255], v6, s[96:99], s18 offen offset:960
    s_mul_i32 s17, s7, 4096
    v_lshlrev_b32 v11, 4, v2
    v_add_u32 v12, s17, v11
    s_lshl_b32 s17, s7, 10
    v_add_u32 v11, s17, v11
    s_waitcnt vmcnt(30)
    v_mfma_f32_16x16x32_bf16 v[16:19], a[0:3], v[128:131], 0
    v_mfma_f32_16x16x32_bf16 v[20:23], a[4:7], v[128:131], 0
    v_mfma_f32_16x16x32_bf16 v[24:27], a[0:3], v[132:135], 0
    v_mfma_f32_16x16x32_bf16 v[28:31], a[4:7], v[132:135], 0
    buffer_load_dwordx4 v[128:131], v5, s[96:99], s18 offen offset:1024
    buffer_load_dwordx4 v[132:135], v6, s[96:99], s18 offen offset:1024
    s_waitcnt vmcnt(30)
    v_mfma_f32_16x16x32_bf16 v[16:19], a[8:11], v[136:139], v[16:19]
    v_mfma_f32_16x16x32_bf16 v[20:23], a[12:15], v[136:139], v[20:23]
    v_mfma_f32_16x16x32_bf16 v[24:27], a[8:11], v[140:143], v[24:27]
    v_mfma_f32_16x16x32_bf16 v[28:31], a[12:15], v[140:143], v[28:31]
    buffer_load_dwordx4 v[136:139], v5, s[96:99], s18 offen offset:1088
    buffer_load_dwordx4 v[140:143], v6, s[96:99], s18 offen offset:1088
    s_waitcnt vmcnt(30)
    v_mfma_f32_16x16x32_bf16 v[16:19], a[16:19], v[144:147], v[16:19]
    v_mfma_f32_16x16x32_bf16 v[20:23], a[20:23], v[144:147], v[20:23]
    v_mfma_f32_16x16x32_bf16 v[24:27], a[16:19], v[148:151], v[24:27]
    v_mfma_f32_16x16x32_bf16 v[28:31], a[20:23], v[148:151], v[28:31]
    buffer_load_dwordx4 v[144:147], v5, s[96:99], s18 offen offset:1152
    buffer_load_dwordx4 v[148:151], v6, s[96:99], s18 offen offset:1152
    s_waitcnt vmcnt(30)
    v_mfma_f32_16x16x32_bf16 v[16:19], a[24:27], v[152:155], v[16:19]
    v_mfma_f32_16x16x32_bf16 v[20:23], a[28:31], v[152:155], v[20:23]
    v_mfma_f32_16x16x32_bf16 v[24:27], a[24:27], v[156:159], v[24:27]
    v_mfma_f32_16x16x32_bf16 v[28:31], a[28:31], v[156:159], v[28:31]
    buffer_load_dwordx4 v[152:155], v5, s[96:99], s18 offen offset:1216
    buffer_load_dwordx4 v[156:159], v6, s[96:99], s18 offen offset:1216
    s_waitcnt vmcnt(30)
    v_mfma_f32_16x16x32_bf16 v[16:19], a[32:35], v[160:163], v[16:19]
    v_mfma_f32_16x16x32_bf16 v[20:23], a[36:39], v[160:163], v[20:23]
    v_mfma_f32_16x16x32_bf16 v[24:27], a[32:35], v[164:167], v[24:27]
    v_mfma_f32_16x16x32_bf16 v[28:31], a[36:39], v[164:167], v[28:31]
    buffer_load_dwordx4 v[160:163], v5, s[96:99], s18 offen offset:1280
    buffer_load_dwordx4 v[164:167], v6, s[96:99], s18 offen offset:1280
    s_waitcnt vmcnt(30)
    v_mfma_f32_16x16x32_bf16 v[16:19], a[40:43], v[168:171], v[16:19]
    v_mfma_f32_16x16x32_bf16 v[20:23], a[44:47], v[168:171], v[20:23]
    v_mfma_f32_16x16x32_bf16 v[24:27], a[40:43], v[172:175], v[24:27]
    v_mfma_f32_16x16x32_bf16 v[28:31], a[44:47], v[172:175], v[28:31]
    buffer_load_dwordx4 v[168:171], v5, s[96:99], s18 offen offset:1344
    buffer_load_dwordx4 v[172:175], v6, s[96:99], s18 offen offset:1344
    s_waitcnt vmcnt(30)
    v_mfma_f32_16x16x32_bf16 v[16:19], a[48:51], v[176:179], v[16:19]
    v_mfma_f32_16x16x32_bf16 v[20:23], a[52:55], v[176:179], v[20:23]
    v_mfma_f32_16x16x32_bf16 v[24:27], a[48:51], v[180:183], v[24:27]
    v_mfma_f32_16x16x32_bf16 v[28:31], a[52:55], v[180:183], v[28:31]
    buffer_load_dwordx4 v[176:179], v5, s[96:99], s18 offen offset:1408
    buffer_load_dwordx4 v[180:183], v6, s[96:99], s18 offen offset:1408
    s_waitcnt vmcnt(30)
    v_mfma_f32_16x16x32_bf16 v[16:19], a[56:59], v[184:187], v[16:19]
    v_mfma_f32_16x16x32_bf16 v[20:23], a[60:63], v[184:187], v[20:23]
    v_mfma_f32_16x16x32_bf16 v[24:27], a[56:59], v[188:191], v[24:27]
    v_mfma_f32_16x16x32_bf16 v[28:31], a[60:63], v[188:191], v[28:31]
    buffer_load_dwordx4 v[184:187], v5, s[96:99], s18 offen offset:1472
    buffer_load_dwordx4 v[188:191], v6, s[96:99], s18 offen offset:1472
    s_waitcnt vmcnt(30)
    v_mfma_f32_16x16x32_bf16 v[16:19], a[64:67], v[192:195], v[16:19]
    v_mfma_f32_16x16x32_bf16 v[20:23], a[68:71], v[192:195], v[20:23]
    v_mfma_f32_16x16x32_bf16 v[24:27], a[64:67], v[196:199], v[24:27]
    v_mfma_f32_16x16x32_bf16 v[28:31], a[68:71], v[196:199], v[28:31]
    buffer_load_dwordx4 v[192:195], v5, s[96:99], s18 offen offset:1536
    buffer_load_dwordx4 v[196:199], v6, s[96:99], s18 offen offset:1536
    s_waitcnt vmcnt(30)
    v_mfma_f32_16x16x32_bf16 v[16:19], a[72:75], v[200:203], v[16:19]
    v_mfma_f32_16x16x32_bf16 v[20:23], a[76:79], v[200:203], v[20:23]
    v_mfma_f32_16x16x32_bf16 v[24:27], a[72:75], v[204:207], v[24:27]
    v_mfma_f32_16x16x32_bf16 v[28:31], a[76:79], v[204:207], v[28:31]
    buffer_load_dwordx4 v[200:203], v5, s[96:99], s18 offen offset:1600
    buffer_load_dwordx4 v[204:207], v6, s[96:99], s18 offen offset:1600
    s_waitcnt vmcnt(30)
    v_mfma_f32_16x16x32_bf16 v[16:19], a[80:83], v[208:211], v[16:19]
    v_mfma_f32_16x16x32_bf16 v[20:23], a[84:87], v[208:211], v[20:23]
    v_mfma_f32_16x16x32_bf16 v[24:27], a[80:83], v[212:215], v[24:27]
    v_mfma_f32_16x16x32_bf16 v[28:31], a[84:87], v[212:215], v[28:31]
    buffer_load_dwordx4 v[208:211], v5, s[96:99], s18 offen offset:1664
    buffer_load_dwordx4 v[212:215], v6, s[96:99], s18 offen offset:1664
    s_waitcnt vmcnt(30)
    v_mfma_f32_16x16x32_bf16 v[16:19], a[88:91], v[216:219], v[16:19]
    v_mfma_f32_16x16x32_bf16 v[20:23], a[92:95], v[216:219], v[20:23]
    v_mfma_f32_16x16x32_bf16 v[24:27], a[88:91], v[220:223], v[24:27]
    v_mfma_f32_16x16x32_bf16 v[28:31], a[92:95], v[220:223], v[28:31]
    buffer_load_dwordx4 v[216:219], v5, s[96:99], s18 offen offset:1728
    buffer_load_dwordx4 v[220:223], v6, s[96:99], s18 offen offset:1728
    s_waitcnt vmcnt(30)
    v_mfma_f32_16x16x32_bf16 v[16:19], a[96:99], v[224:227], v[16:19]
    v_mfma_f32_16x16x32_bf16 v[20:23], a[100:103], v[224:227], v[20:23]
    v_mfma_f32_16x16x32_bf16 v[24:27], a[96:99], v[228:231], v[24:27]
    v_mfma_f32_16x16x32_bf16 v[28:31], a[100:103], v[228:231], v[28:31]
    buffer_load_dwordx4 v[224:227], v5, s[96:99], s18 offen offset:1792
    buffer_load_dwordx4 v[228:231], v6, s[96:99], s18 offen offset:1792
    s_waitcnt vmcnt(30)
    v_mfma_f32_16x16x32_bf16 v[16:19], a[104:107], v[232:235], v[16:19]
    v_mfma_f32_16x16x32_bf16 v[20:23], a[108:111], v[232:235], v[20:23]
    v_mfma_f32_16x16x32_bf16 v[24:27], a[104:107], v[236:239], v[24:27]
    v_mfma_f32_16x16x32_bf16 v[28:31], a[108:111], v[236:239], v[28:31]
    buffer_load_dwordx4 v[232:235], v5, s[96:99], s18 offen offset:1856
    buffer_load_dwordx4 v[236:239], v6, s[96:99], s18 offen offset:1856
    s_waitcnt vmcnt(30)
    v_mfma_f32_16x16x32_bf16 v[16:19], a[112:115], v[240:243], v[16:19]
    v_mfma_f32_16x16x32_bf16 v[20:23], a[116:119], v[240:243], v[20:23]
    v_mfma_f32_16x16x32_bf16 v[24:27], a[112:115], v[244:247], v[24:27]
    v_mfma_f32_16x16x32_bf16 v[28:31], a[116:119], v[244:247], v[28:31]
    buffer_load_dwordx4 v[240:243], v5, s[96:99], s18 offen offset:1920
    buffer_load_dwordx4 v[244:247], v6, s[96:99], s18 offen offset:1920
    s_waitcnt vmcnt(30)
    v_mfma_f32_16x16x32_bf16 v[16:19], a[120:123], v[248:251], v[16:19]
    v_mfma_f32_16x16x32_bf16 v[20:23], a[124:127], v[248:251], v[20:23]
    v_mfma_f32_16x16x32_bf16 v[24:27], a[120:123], v[252:255], v[24:27]
    v_mfma_f32_16x16x32_bf16 v[28:31], a[124:127], v[252:255], v[28:31]
    buffer_load_dwordx4 v[248:251], v5, s[96:99], s18 offen offset:1984
    buffer_load_dwordx4 v[252:255], v6, s[96:99], s18 offen offset:1984
    s_waitcnt vmcnt(30)
    v_mfma_f32_16x16x32_bf16 v[16:19], a[128:131], v[128:131], v[16:19]
    v_mfma_f32_16x16x32_bf16 v[20:23], a[132:135], v[128:131], v[20:23]
    v_mfma_f32_16x16x32_bf16 v[24:27], a[128:131], v[132:135], v[24:27]
    v_mfma_f32_16x16x32_bf16 v[28:31], a[132:135], v[132:135], v[28:31]
    s_waitcnt vmcnt(28)
    v_mfma_f32_16x16x32_bf16 v[16:19], a[136:139], v[136:139], v[16:19]
    v_mfma_f32_16x16x32_bf16 v[20:23], a[140:143], v[136:139], v[20:23]
    v_mfma_f32_16x16x32_bf16 v[24:27], a[136:139], v[140:143], v[24:27]
    v_mfma_f32_16x16x32_bf16 v[28:31], a[140:143], v[140:143], v[28:31]
    s_waitcnt vmcnt(26)
    v_mfma_f32_16x16x32_bf16 v[16:19], a[144:147], v[144:147], v[16:19]
    v_mfma_f32_16x16x32_bf16 v[20:23], a[148:151], v[144:147], v[20:23]
    v_mfma_f32_16x16x32_bf16 v[24:27], a[144:147], v[148:151], v[24:27]
    v_mfma_f32_16x16x32_bf16 v[28:31], a[148:151], v[148:151], v[28:31]
    s_waitcnt vmcnt(24)
    v_mfma_f32_16x16x32_bf16 v[16:19], a[152:155], v[152:155], v[16:19]
    v_mfma_f32_16x16x32_bf16 v[20:23], a[156:159], v[152:155], v[20:23]
    v_mfma_f32_16x16x32_bf16 v[24:27], a[152:155], v[156:159], v[24:27]
    v_mfma_f32_16x16x32_bf16 v[28:31], a[156:159], v[156:159], v[28:31]
    s_waitcnt vmcnt(22)
    v_mfma_f32_16x16x32_bf16 v[16:19], a[160:163], v[160:163], v[16:19]
    v_mfma_f32_16x16x32_bf16 v[20:23], a[164:167], v[160:163], v[20:23]
    v_mfma_f32_16x16x32_bf16 v[24:27], a[160:163], v[164:167], v[24:27]
    v_mfma_f32_16x16x32_bf16 v[28:31], a[164:167], v[164:167], v[28:31]
    s_waitcnt vmcnt(20)
    v_mfma_f32_16x16x32_bf16 v[16:19], a[168:171], v[168:171], v[16:19]
    v_mfma_f32_16x16x32_bf16 v[20:23], a[172:175], v[168:171], v[20:23]
    v_mfma_f32_16x16x32_bf16 v[24:27], a[168:171], v[172:175], v[24:27]
    v_mfma_f32_16x16x32_bf16 v[28:31], a[172:175], v[172:175], v[28:31]
    s_waitcnt vmcnt(18)
    v_mfma_f32_16x16x32_bf16 v[16:19], a[176:179], v[176:179], v[16:19]
    v_mfma_f32_16x16x32_bf16 v[20:23], a[180:183], v[176:179], v[20:23]
    v_mfma_f32_16x16x32_bf16 v[24:27], a[176:179], v[180:183], v[24:27]
    v_mfma_f32_16x16x32_bf16 v[28:31], a[180:183], v[180:183], v[28:31]
    s_waitcnt vmcnt(16)
    v_mfma_f32_16x16x32_bf16 v[16:19], a[184:187], v[184:187], v[16:19]
    v_mfma_f32_16x16x32_bf16 v[20:23], a[188:191], v[184:187], v[20:23]
    v_mfma_f32_16x16x32_bf16 v[24:27], a[184:187], v[188:191], v[24:27]
    v_mfma_f32_16x16x32_bf16 v[28:31], a[188:191], v[188:191], v[28:31]
    s_waitcnt vmcnt(14)
    v_mfma_f32_16x16x32_bf16 v[16:19], a[192:195], v[192:195], v[16:19]
    v_mfma_f32_16x16x32_bf16 v[20:23], a[196:199], v[192:195], v[20:23]
    v_mfma_f32_16x16x32_bf16 v[24:27], a[192:195], v[196:199], v[24:27]
    v_mfma_f32_16x16x32_bf16 v[28:31], a[196:199], v[196:199], v[28:31]
    s_waitcnt vmcnt(12)
    v_mfma_f32_16x16x32_bf16 v[16:19], a[200:203], v[200:203], v[16:19]
    v_mfma_f32_16x16x32_bf16 v[20:23], a[204:207], v[200:203], v[20:23]
    v_mfma_f32_16x16x32_bf16 v[24:27], a[200:203], v[204:207], v[24:27]
    v_mfma_f32_16x16x32_bf16 v[28:31], a[204:207], v[204:207], v[28:31]
    s_waitcnt vmcnt(10)
    v_mfma_f32_16x16x32_bf16 v[16:19], a[208:211], v[208:211], v[16:19]
    v_mfma_f32_16x16x32_bf16 v[20:23], a[212:215], v[208:211], v[20:23]
    v_mfma_f32_16x16x32_bf16 v[24:27], a[208:211], v[212:215], v[24:27]
    v_mfma_f32_16x16x32_bf16 v[28:31], a[212:215], v[212:215], v[28:31]
    s_waitcnt vmcnt(8)
    v_mfma_f32_16x16x32_bf16 v[16:19], a[216:219], v[216:219], v[16:19]
    v_mfma_f32_16x16x32_bf16 v[20:23], a[220:223], v[216:219], v[20:23]
    v_mfma_f32_16x16x32_bf16 v[24:27], a[216:219], v[220:223], v[24:27]
    v_mfma_f32_16x16x32_bf16 v[28:31], a[220:223], v[220:223], v[28:31]
    s_waitcnt vmcnt(6)
    v_mfma_f32_16x16x32_bf16 v[16:19], a[224:227], v[224:227], v[16:19]
    v_mfma_f32_16x16x32_bf16 v[20:23], a[228:231], v[224:227], v[20:23]
    v_mfma_f32_16x16x32_bf16 v[24:27], a[224:227], v[228:231], v[24:27]
    v_mfma_f32_16x16x32_bf16 v[28:31], a[228:231], v[228:231], v[28:31]
    s_waitcnt vmcnt(4)
    v_mfma_f32_16x16x32_bf16 v[16:19], a[232:235], v[232:235], v[16:19]
    v_mfma_f32_16x16x32_bf16 v[20:23], a[236:239], v[232:235], v[20:23]
    v_mfma_f32_16x16x32_bf16 v[24:27], a[232:235], v[236:239], v[24:27]
    v_mfma_f32_16x16x32_bf16 v[28:31], a[236:239], v[236:239], v[28:31]
    s_waitcnt vmcnt(2)
    v_mfma_f32_16x16x32_bf16 v[16:19], a[240:243], v[240:243], v[16:19]
    v_mfma_f32_16x16x32_bf16 v[20:23], a[244:247], v[240:243], v[20:23]
    v_mfma_f32_16x16x32_bf16 v[24:27], a[240:243], v[244:247], v[24:27]
    v_mfma_f32_16x16x32_bf16 v[28:31], a[244:247], v[244:247], v[28:31]
    s_waitcnt vmcnt(0)
    v_mfma_f32_16x16x32_bf16 v[16:19], a[248:251], v[248:251], v[16:19]
    v_mfma_f32_16x16x32_bf16 v[20:23], a[252:255], v[248:251], v[20:23]
    v_mfma_f32_16x16x32_bf16 v[24:27], a[248:251], v[252:255], v[24:27]
    v_mfma_f32_16x16x32_bf16 v[28:31], a[252:255], v[252:255], v[28:31]
    s_nop 7
    s_nop 1
    ds_write_b128 v12, v[16:19] offset:0
    ds_write_b128 v12, v[20:23] offset:1024
    ds_write_b128 v12, v[24:27] offset:2048
    ds_write_b128 v12, v[28:31] offset:3072
    s_waitcnt lgkmcnt(0)
    s_barrier
    ds_read_b128 v[16:19], v11 offset:0
    ds_read_b128 v[20:23], v11 offset:4096
    ds_read_b128 v[24:27], v11 offset:8192
    ds_read_b128 v[28:31], v11 offset:12288
    s_lshr_b32 s17, s7, 1
    s_add_u32 s17, s17, s19
    s_lshl_b32 s17, s17, 4
    s_lshl_b32 s16, s4, 5
    s_add_u32 s16, s16, s17
    s_mul_i32 s16, s16, 2560
    s_lshl_b32 s17, s5, 6
    s_add_u32 s16, s16, s17
    s_and_b32 s17, s7, 1
    s_lshl_b32 s17, s17, 5
    s_add_u32 s16, s16, s17
    v_mul_u32_u24 v5, 2560, v3
    v_lshl_add_u32 v5, v4, 3, v5
    s_waitcnt lgkmcnt(0)
    v_add_f32 v16, v16, v20
    v_add_f32 v24, v24, v28
    v_add_f32 v17, v17, v21
    v_add_f32 v25, v25, v29
    v_add_f32 v18, v18, v22
    v_add_f32 v26, v26, v30
    v_add_f32 v19, v19, v23
    v_add_f32 v27, v27, v31
    v_add_f32 v16, v16, v24
    v_add_f32 v17, v17, v25
    v_add_f32 v18, v18, v26
    v_add_f32 v19, v19, v27
    v_cvt_pk_bf16_f32 v16, v16, v17
    v_cvt_pk_bf16_f32 v17, v18, v19
    buffer_store_dwordx2 v[16:17], v5, s[12:15], s16 offen
fine2_end:
    s_endpgm
fine1:
    s_load_dwordx2 s[12:13], s[0:1], 80
    s_waitcnt lgkmcnt(0)
    s_mov_b32 s14, 5242880
    s_mov_b32 s15, 0x00020000
    s_sub_u32 s5, s5, 8
    s_and_b32 s19, s5, 1
    s_lshr_b32 s5, s5, 1
    v_and_b32 v3, 15, v2
    v_lshrrev_b32 v4, 4, v2
    v_lshlrev_b32 v5, 13, v3
    v_lshl_add_u32 v5, v4, 4, v5
    v_add_u32 v6, 0x20000, v5
    s_lshl_b32 s16, s5, 18
    s_lshl_b32 s17, s7, 11
    s_add_u32 s16, s16, s17
    s_add_u32 s16, s16, 16777216
    s_lshl_b32 s18, s4, 18
    s_add_u32 s18, s18, s17
    s_add_u32 s18, s18, 117440512
    s_lshl_b32 s17, s19, 17
    s_add_u32 s18, s18, s17
    buffer_load_dwordx4 a[0:3], v5, s[96:99], s16 offen offset:0
    buffer_load_dwordx4 a[4:7], v6, s[96:99], s16 offen offset:0
    buffer_load_dwordx4 a[8:11], v5, s[96:99], s16 offen offset:64
    buffer_load_dwordx4 a[12:15], v6, s[96:99], s16 offen offset:64
    buffer_load_dwordx4 a[16:19], v5, s[96:99], s16 offen offset:128
    buffer_load_dwordx4 a[20:23], v6, s[96:99], s16 offen offset:128
    buffer_load_dwordx4 a[24:27], v5, s[96:99], s16 offen offset:192
    buffer_load_dwordx4 a[28:31], v6, s[96:99], s16 offen offset:192
    buffer_load_dwordx4 a[32:35], v5, s[96:99], s16 offen offset:256
    buffer_load_dwordx4 a[36:39], v6, s[96:99], s16 offen offset:256
    buffer_load_dwordx4 a[40:43], v5, s[96:99], s16 offen offset:320
    buffer_load_dwordx4 a[44:47], v6, s[96:99], s16 offen offset:320
    buffer_load_dwordx4 a[48:51], v5, s[96:99], s16 offen offset:384
    buffer_load_dwordx4 a[52:55], v6, s[96:99], s16 offen offset:384
    buffer_load_dwordx4 a[56:59], v5, s[96:99], s16 offen offset:448
    buffer_load_dwordx4 a[60:63], v6, s[96:99], s16 offen offset:448
    buffer_load_dwordx4 a[64:67], v5, s[96:99], s16 offen offset:512
    buffer_load_dwordx4 a[68:71], v6, s[96:99], s16 offen offset:512
    buffer_load_dwordx4 a[72:75], v5, s[96:99], s16 offen offset:576
    buffer_load_dwordx4 a[76:79], v6, s[96:99], s16 offen offset:576
    buffer_load_dwordx4 a[80:83], v5, s[96:99], s16 offen offset:640
    buffer_load_dwordx4 a[84:87], v6, s[96:99], s16 offen offset:640
    buffer_load_dwordx4 a[88:91], v5, s[96:99], s16 offen offset:704
    buffer_load_dwordx4 a[92:95], v6, s[96:99], s16 offen offset:704
    buffer_load_dwordx4 a[96:99], v5, s[96:99], s16 offen offset:768
    buffer_load_dwordx4 a[100:103], v6, s[96:99], s16 offen offset:768
    buffer_load_dwordx4 a[104:107], v5, s[96:99], s16 offen offset:832
    buffer_load_dwordx4 a[108:111], v6, s[96:99], s16 offen offset:832
    buffer_load_dwordx4 a[112:115], v5, s[96:99], s16 offen offset:896
    buffer_load_dwordx4 a[116:119], v6, s[96:99], s16 offen offset:896
    buffer_load_dwordx4 a[120:123], v5, s[96:99], s16 offen offset:960
    buffer_load_dwordx4 a[124:127], v6, s[96:99], s16 offen offset:960
    buffer_load_dwordx4 a[128:131], v5, s[96:99], s16 offen offset:1024
    buffer_load_dwordx4 a[132:135], v6, s[96:99], s16 offen offset:1024
    buffer_load_dwordx4 a[136:139], v5, s[96:99], s16 offen offset:1088
    buffer_load_dwordx4 a[140:143], v6, s[96:99], s16 offen offset:1088
    buffer_load_dwordx4 a[144:147], v5, s[96:99], s16 offen offset:1152
    buffer_load_dwordx4 a[148:151], v6, s[96:99], s16 offen offset:1152
    buffer_load_dwordx4 a[152:155], v5, s[96:99], s16 offen offset:1216
    buffer_load_dwordx4 a[156:159], v6, s[96:99], s16 offen offset:1216
    buffer_load_dwordx4 a[160:163], v5, s[96:99], s16 offen offset:1280
    buffer_load_dwordx4 a[164:167], v6, s[96:99], s16 offen offset:1280
    buffer_load_dwordx4 a[168:171], v5, s[96:99], s16 offen offset:1344
    buffer_load_dwordx4 a[172:175], v6, s[96:99], s16 offen offset:1344
    buffer_load_dwordx4 a[176:179], v5, s[96:99], s16 offen offset:1408
    buffer_load_dwordx4 a[180:183], v6, s[96:99], s16 offen offset:1408
    buffer_load_dwordx4 a[184:187], v5, s[96:99], s16 offen offset:1472
    buffer_load_dwordx4 a[188:191], v6, s[96:99], s16 offen offset:1472
    buffer_load_dwordx4 a[192:195], v5, s[96:99], s16 offen offset:1536
    buffer_load_dwordx4 a[196:199], v6, s[96:99], s16 offen offset:1536
    buffer_load_dwordx4 a[200:203], v5, s[96:99], s16 offen offset:1600
    buffer_load_dwordx4 a[204:207], v6, s[96:99], s16 offen offset:1600
    buffer_load_dwordx4 a[208:211], v5, s[96:99], s16 offen offset:1664
    buffer_load_dwordx4 a[212:215], v6, s[96:99], s16 offen offset:1664
    buffer_load_dwordx4 a[216:219], v5, s[96:99], s16 offen offset:1728
    buffer_load_dwordx4 a[220:223], v6, s[96:99], s16 offen offset:1728
    buffer_load_dwordx4 a[224:227], v5, s[96:99], s16 offen offset:1792
    buffer_load_dwordx4 a[228:231], v6, s[96:99], s16 offen offset:1792
    buffer_load_dwordx4 a[232:235], v5, s[96:99], s16 offen offset:1856
    buffer_load_dwordx4 a[236:239], v6, s[96:99], s16 offen offset:1856
    buffer_load_dwordx4 a[240:243], v5, s[96:99], s16 offen offset:1920
    buffer_load_dwordx4 a[244:247], v6, s[96:99], s16 offen offset:1920
    buffer_load_dwordx4 a[248:251], v5, s[96:99], s16 offen offset:1984
    buffer_load_dwordx4 a[252:255], v6, s[96:99], s16 offen offset:1984
    s_lshl_b32 s3, s4, 8
    s_add_u32 s3, s3, 152584192
    v_mov_b32 v8, s3
    v_mov_b32 v9, 8
    s_cmp_lg_u32 s7, 0
    s_cbranch_scc1 wt9_d
    s_mov_b32 s37, 0
wt9_l:
    buffer_load_dword v10, v8, s[96:99], 0 offen sc1
    s_waitcnt vmcnt(0)
    v_cmp_gt_u32 vcc, v9, v10
    s_nop 1
    s_cbranch_vccz wt9_d
    s_add_u32 s37, s37, 1
    s_cmp_gt_u32 s37, 0x20000
    s_cbranch_scc1 wt9_d
    s_sleep 16
    s_branch wt9_l
wt9_d:
    s_barrier
    buffer_load_dwordx4 v[128:131], v5, s[96:99], s18 offen offset:0
    buffer_load_dwordx4 v[132:135], v5, s[96:99], s18 offen offset:64
    buffer_load_dwordx4 v[136:139], v5, s[96:99], s18 offen offset:128
    buffer_load_dwordx4 v[140:143], v5, s[96:99], s18 offen offset:192
    buffer_load_dwordx4 v[144:147], v5, s[96:99], s18 offen offset:256
    buffer_load_dwordx4 v[148:151], v5, s[96:99], s18 offen offset:320
    buffer_load_dwordx4 v[152:155], v5, s[96:99], s18 offen offset:384
    buffer_load_dwordx4 v[156:159], v5, s[96:99], s18 offen offset:448
    buffer_load_dwordx4 v[160:163], v5, s[96:99], s18 offen offset:512
    buffer_load_dwordx4 v[164:167], v5, s[96:99], s18 offen offset:576
    buffer_load_dwordx4 v[168:171], v5, s[96:99], s18 offen offset:640
    buffer_load_dwordx4 v[172:175], v5, s[96:99], s18 offen offset:704
    buffer_load_dwordx4 v[176:179], v5, s[96:99], s18 offen offset:768
    buffer_load_dwordx4 v[180:183], v5, s[96:99], s18 offen offset:832
    buffer_load_dwordx4 v[184:187], v5, s[96:99], s18 offen offset:896
    buffer_load_dwordx4 v[188:191], v5, s[96:99], s18 offen offset:960
    buffer_load_dwordx4 v[192:195], v5, s[96:99], s18 offen offset:1024
    buffer_load_dwordx4 v[196:199], v5, s[96:99], s18 offen offset:1088
    buffer_load_dwordx4 v[200:203], v5, s[96:99], s18 offen offset:1152
    buffer_load_dwordx4 v[204:207], v5, s[96:99], s18 offen offset:1216
    buffer_load_dwordx4 v[208:211], v5, s[96:99], s18 offen offset:1280
    buffer_load_dwordx4 v[212:215], v5, s[96:99], s18 offen offset:1344
    buffer_load_dwordx4 v[216:219], v5, s[96:99], s18 offen offset:1408
    buffer_load_dwordx4 v[220:223], v5, s[96:99], s18 offen offset:1472
    buffer_load_dwordx4 v[224:227], v5, s[96:99], s18 offen offset:1536
    buffer_load_dwordx4 v[228:231], v5, s[96:99], s18 offen offset:1600
    buffer_load_dwordx4 v[232:235], v5, s[96:99], s18 offen offset:1664
    buffer_load_dwordx4 v[236:239], v5, s[96:99], s18 offen offset:1728
    buffer_load_dwordx4 v[240:243], v5, s[96:99], s18 offen offset:1792
    buffer_load_dwordx4 v[244:247], v5, s[96:99], s18 offen offset:1856
    buffer_load_dwordx4 v[248:251], v5, s[96:99], s18 offen offset:1920
    buffer_load_dwordx4 v[252:255], v5, s[96:99], s18 offen offset:1984
    s_mul_i32 s17, s7, 2048
    v_lshlrev_b32 v11, 4, v2
    v_add_u32 v12, s17, v11
    s_lshl_b32 s17, s7, 10
    v_add_u32 v11, s17, v11
    s_waitcnt vmcnt(31)
    v_mfma_f32_16x16x32_bf16 v[16:19], a[0:3], v[128:131], 0
    v_mfma_f32_16x16x32_bf16 v[20:23], a[4:7], v[128:131], 0
    s_waitcnt vmcnt(30)
    v_mfma_f32_16x16x32_bf16 v[16:19], a[8:11], v[132:135], v[16:19]
    v_mfma_f32_16x16x32_bf16 v[20:23], a[12:15], v[132:135], v[20:23]
    s_waitcnt vmcnt(29)
    v_mfma_f32_16x16x32_bf16 v[16:19], a[16:19], v[136:139], v[16:19]
    v_mfma_f32_16x16x32_bf16 v[20:23], a[20:23], v[136:139], v[20:23]
    s_waitcnt vmcnt(28)
    v_mfma_f32_16x16x32_bf16 v[16:19], a[24:27], v[140:143], v[16:19]
    v_mfma_f32_16x16x32_bf16 v[20:23], a[28:31], v[140:143], v[20:23]
    s_waitcnt vmcnt(27)
    v_mfma_f32_16x16x32_bf16 v[16:19], a[32:35], v[144:147], v[16:19]
    v_mfma_f32_16x16x32_bf16 v[20:23], a[36:39], v[144:147], v[20:23]
    s_waitcnt vmcnt(26)
    v_mfma_f32_16x16x32_bf16 v[16:19], a[40:43], v[148:151], v[16:19]
    v_mfma_f32_16x16x32_bf16 v[20:23], a[44:47], v[148:151], v[20:23]
    s_waitcnt vmcnt(25)
    v_mfma_f32_16x16x32_bf16 v[16:19], a[48:51], v[152:155], v[16:19]
    v_mfma_f32_16x16x32_bf16 v[20:23], a[52:55], v[152:155], v[20:23]
    s_waitcnt vmcnt(24)
    v_mfma_f32_16x16x32_bf16 v[16:19], a[56:59], v[156:159], v[16:19]
    v_mfma_f32_16x16x32_bf16 v[20:23], a[60:63], v[156:159], v[20:23]
    s_waitcnt vmcnt(23)
    v_mfma_f32_16x16x32_bf16 v[16:19], a[64:67], v[160:163], v[16:19]
    v_mfma_f32_16x16x32_bf16 v[20:23], a[68:71], v[160:163], v[20:23]
    s_waitcnt vmcnt(22)
    v_mfma_f32_16x16x32_bf16 v[16:19], a[72:75], v[164:167], v[16:19]
    v_mfma_f32_16x16x32_bf16 v[20:23], a[76:79], v[164:167], v[20:23]
    s_waitcnt vmcnt(21)
    v_mfma_f32_16x16x32_bf16 v[16:19], a[80:83], v[168:171], v[16:19]
    v_mfma_f32_16x16x32_bf16 v[20:23], a[84:87], v[168:171], v[20:23]
    s_waitcnt vmcnt(20)
    v_mfma_f32_16x16x32_bf16 v[16:19], a[88:91], v[172:175], v[16:19]
    v_mfma_f32_16x16x32_bf16 v[20:23], a[92:95], v[172:175], v[20:23]
    s_waitcnt vmcnt(19)
    v_mfma_f32_16x16x32_bf16 v[16:19], a[96:99], v[176:179], v[16:19]
    v_mfma_f32_16x16x32_bf16 v[20:23], a[100:103], v[176:179], v[20:23]
    s_waitcnt vmcnt(18)
    v_mfma_f32_16x16x32_bf16 v[16:19], a[104:107], v[180:183], v[16:19]
    v_mfma_f32_16x16x32_bf16 v[20:23], a[108:111], v[180:183], v[20:23]
    s_waitcnt vmcnt(17)
    v_mfma_f32_16x16x32_bf16 v[16:19], a[112:115], v[184:187], v[16:19]
    v_mfma_f32_16x16x32_bf16 v[20:23], a[116:119], v[184:187], v[20:23]
    s_waitcnt vmcnt(16)
    v_mfma_f32_16x16x32_bf16 v[16:19], a[120:123], v[188:191], v[16:19]
    v_mfma_f32_16x16x32_bf16 v[20:23], a[124:127], v[188:191], v[20:23]
    s_waitcnt vmcnt(15)
    v_mfma_f32_16x16x32_bf16 v[16:19], a[128:131], v[192:195], v[16:19]
    v_mfma_f32_16x16x32_bf16 v[20:23], a[132:135], v[192:195], v[20:23]
    s_waitcnt vmcnt(14)
    v_mfma_f32_16x16x32_bf16 v[16:19], a[136:139], v[196:199], v[16:19]
    v_mfma_f32_16x16x32_bf16 v[20:23], a[140:143], v[196:199], v[20:23]
    s_waitcnt vmcnt(13)
    v_mfma_f32_16x16x32_bf16 v[16:19], a[144:147], v[200:203], v[16:19]
    v_mfma_f32_16x16x32_bf16 v[20:23], a[148:151], v[200:203], v[20:23]
    s_waitcnt vmcnt(12)
    v_mfma_f32_16x16x32_bf16 v[16:19], a[152:155], v[204:207], v[16:19]
    v_mfma_f32_16x16x32_bf16 v[20:23], a[156:159], v[204:207], v[20:23]
    s_waitcnt vmcnt(11)
    v_mfma_f32_16x16x32_bf16 v[16:19], a[160:163], v[208:211], v[16:19]
    v_mfma_f32_16x16x32_bf16 v[20:23], a[164:167], v[208:211], v[20:23]
    s_waitcnt vmcnt(10)
    v_mfma_f32_16x16x32_bf16 v[16:19], a[168:171], v[212:215], v[16:19]
    v_mfma_f32_16x16x32_bf16 v[20:23], a[172:175], v[212:215], v[20:23]
    s_waitcnt vmcnt(9)
    v_mfma_f32_16x16x32_bf16 v[16:19], a[176:179], v[216:219], v[16:19]
    v_mfma_f32_16x16x32_bf16 v[20:23], a[180:183], v[216:219], v[20:23]
    s_waitcnt vmcnt(8)
    v_mfma_f32_16x16x32_bf16 v[16:19], a[184:187], v[220:223], v[16:19]
    v_mfma_f32_16x16x32_bf16 v[20:23], a[188:191], v[220:223], v[20:23]
    s_waitcnt vmcnt(7)
    v_mfma_f32_16x16x32_bf16 v[16:19], a[192:195], v[224:227], v[16:19]
    v_mfma_f32_16x16x32_bf16 v[20:23], a[196:199], v[224:227], v[20:23]
    s_waitcnt vmcnt(6)
    v_mfma_f32_16x16x32_bf16 v[16:19], a[200:203], v[228:231], v[16:19]
    v_mfma_f32_16x16x32_bf16 v[20:23], a[204:207], v[228:231], v[20:23]
    s_waitcnt vmcnt(5)
    v_mfma_f32_16x16x32_bf16 v[16:19], a[208:211], v[232:235], v[16:19]
    v_mfma_f32_16x16x32_bf16 v[20:23], a[212:215], v[232:235], v[20:23]
    s_waitcnt vmcnt(4)
    v_mfma_f32_16x16x32_bf16 v[16:19], a[216:219], v[236:239], v[16:19]
    v_mfma_f32_16x16x32_bf16 v[20:23], a[220:223], v[236:239], v[20:23]
    s_waitcnt vmcnt(3)
    v_mfma_f32_16x16x32_bf16 v[16:19], a[224:227], v[240:243], v[16:19]
    v_mfma_f32_16x16x32_bf16 v[20:23], a[228:231], v[240:243], v[20:23]
    s_waitcnt vmcnt(2)
    v_mfma_f32_16x16x32_bf16 v[16:19], a[232:235], v[244:247], v[16:19]
    v_mfma_f32_16x16x32_bf16 v[20:23], a[236:239], v[244:247], v[20:23]
    s_waitcnt vmcnt(1)
    v_mfma_f32_16x16x32_bf16 v[16:19], a[240:243], v[248:251], v[16:19]
    v_mfma_f32_16x16x32_bf16 v[20:23], a[244:247], v[248:251], v[20:23]
    s_waitcnt vmcnt(0)
    v_mfma_f32_16x16x32_bf16 v[16:19], a[248:251], v[252:255], v[16:19]
    v_mfma_f32_16x16x32_bf16 v[20:23], a[252:255], v[252:255], v[20:23]
    s_nop 7
    s_nop 1
    ds_write_b128 v12, v[16:19] offset:0
    ds_write_b128 v12, v[20:23] offset:1024
    s_waitcnt lgkmcnt(0)
    s_barrier
    s_cmp_ge_u32 s7, 2
    s_cbranch_scc1 fine1_end
    ds_read_b128 v[16:19], v11 offset:0
    ds_read_b128 v[20:23], v11 offset:2048
    ds_read_b128 v[24:27], v11 offset:4096
    ds_read_b128 v[28:31], v11 offset:6144
    s_lshr_b32 s17, s7, 1
    s_add_u32 s17, s17, s19
    s_lshl_b32 s17, s17, 4
    s_lshl_b32 s16, s4, 5
    s_add_u32 s16, s16, s17
    s_mul_i32 s16, s16, 2560
    s_lshl_b32 s17, s5, 6
    s_add_u32 s16, s16, s17
    s_and_b32 s17, s7, 1
    s_lshl_b32 s17, s17, 5
    s_add_u32 s16, s16, s17
    v_mul_u32_u24 v5, 2560, v3
    v_lshl_add_u32 v5, v4, 3, v5
    s_waitcnt lgkmcnt(0)
    v_add_f32 v16, v16, v20
    v_add_f32 v24, v24, v28
    v_add_f32 v17, v17, v21
    v_add_f32 v25, v25, v29
    v_add_f32 v18, v18, v22
    v_add_f32 v26, v26, v30
    v_add_f32 v19, v19, v23
    v_add_f32 v27, v27, v31
    v_add_f32 v16, v16, v24
    v_add_f32 v17, v17, v25
    v_add_f32 v18, v18, v26
    v_add_f32 v19, v19, v27
    v_cvt_pk_bf16_f32 v16, v16, v17
    v_cvt_pk_bf16_f32 v17, v18, v19
    buffer_store_dwordx2 v[16:17], v5, s[12:15], s16 offen
fine1_end:
    s_endpgm
g2_p0:
    s_load_dwordx2 s[8:9], s[0:1], 96
    s_waitcnt lgkmcnt(0)
    s_mov_b32 s10, 268435456
    s_mov_b32 s11, 0x00020000
    s_load_dwordx2 s[12:13], s[0:1], 80
    s_waitcnt lgkmcnt(0)
    s_mov_b32 s14, 5242880
    s_mov_b32 s15, 0x00020000
    s_mul_i32 s16, s4, 1048576
    s_add_u32 s16, s16, 117440512
    s_mul_i32 s17, s5, 1048576
    s_add_u32 s17, s17, 16777216
    s_mul_i32 s18, s4, 327680
    s_lshl_b32 s19, s5, 8
    s_add_u32 s18, s18, s19
    s_add_u32 s18, s18, 0
    s_mov_b32 s22, 2560
    s_mov_b32 s27, 128
    s_mov_b32 s28, 64
    s_mov_b32 s26, 16384
    s_mov_b32 s20, 8192
    s_mov_b32 s21, 8192
    s_mov_b32 s23, 31
    s_branch g2_go
g2_p1:
    s_load_dwordx2 s[8:9], s[0:1], 96
    s_waitcnt lgkmcnt(0)
    s_mov_b32 s10, 268435456
    s_mov_b32 s11, 0x00020000
    s_load_dwordx2 s[12:13], s[0:1], 80
    s_waitcnt lgkmcnt(0)
    s_mov_b32 s14, 5242880
    s_mov_b32 s15, 0x00020000
    s_mul_i32 s16, s4, 163840
    s_add_u32 s16, s16, 138412032
    s_mul_i32 s17, s5, 163840
    s_add_u32 s17, s17, 26214400
    s_mul_i32 s18, s4, 327680
    s_lshl_b32 s19, s5, 8
    s_add_u32 s18, s18, s19
    s_add_u32 s18, s18, 1280
    s_mov_b32 s22, 2560
    s_mov_b32 s27, 128
    s_mov_b32 s28, 64
    s_mov_b32 s26, 16384
    s_mov_b32 s20, 1280
    s_mov_b32 s21, 1280
    s_mov_b32 s23, 4
    s_branch g2_go
g2_go:
    v_lshrrev_b32 v1, 6, v0
    v_and_b32 v2, 63, v0
    s_nop 0
    v_readfirstlane_b32 s7, v1
    s_cmp_lg_u32 s7, 0
    s_cbranch_scc1 wt10_d
    s_mov_b32 s37, 0
wt10_l:
    buffer_load_dword v252, v250, s[96:99], 0 offen sc1
    s_waitcnt vmcnt(0)
    v_cmp_gt_u32 vcc, v251, v252
    s_nop 1
    s_cbranch_vccz wt10_d
    s_add_u32 s37, s37, 1
    s_cmp_gt_u32 s37, 0x20000
    s_cbranch_scc1 wt10_d
    s_sleep 16
    s_branch wt10_l
wt10_d:
    s_barrier
    v_lshrrev_b32 v3, 2, v2
    v_and_b32 v4, 3, v2
    v_lshrrev_b32 v5, 4, v2
    v_xor_b32 v5, v4, v5
    v_lshlrev_b32 v5, 4, v5
    v_lshl_add_u32 v7, v1, 5, v3
    v_mul_lo_u32 v10, v7, s20
    v_add_u32 v10, v10, v5
    v_mul_lo_u32 v11, v7, s21
    v_add_u32 v11, v11, v5
    s_lshl_b32 s19, s20, 4
    s_add_u32 s30, s16, s19
    s_lshl_b32 s19, s21, 4
    s_add_u32 s31, s17, s19
    s_lshl_b32 s29, s7, 11
    s_add_u32 m0, s29, 0
    s_nop 0
    buffer_load_dwordx4 v10, s[8:11], s16 offen lds
    s_add_u32 m0, s29, 1024
    s_nop 0
    buffer_load_dwordx4 v10, s[8:11], s30 offen lds
    s_add_u32 m0, s29, 8192
    s_nop 0
    buffer_load_dwordx4 v11, s[96:99], s17 offen lds
    s_add_u32 m0, s29, 9216
    s_nop 0
    buffer_load_dwordx4 v11, s[96:99], s31 offen lds
    s_add_u32 s16, s16, 64
    s_add_u32 s17, s17, 64
    s_add_u32 s30, s30, 64
    s_add_u32 s31, s31, 64
    s_add_u32 m0, s29, 16384
    s_nop 0
    buffer_load_dwordx4 v10, s[8:11], s16 offen lds
    s_add_u32 m0, s29, 17408
    s_nop 0
    buffer_load_dwordx4 v10, s[8:11], s30 offen lds
    s_add_u32 m0, s29, 24576
    s_nop 0
    buffer_load_dwordx4 v11, s[96:99], s17 offen lds
    s_add_u32 m0, s29, 25600
    s_nop 0
    buffer_load_dwordx4 v11, s[96:99], s31 offen lds
    s_add_u32 s16, s16, 64
    s_add_u32 s17, s17, 64
    s_add_u32 s30, s30, 64
    s_add_u32 s31, s31, 64
    s_add_u32 m0, s29, 32768
    s_nop 0
    buffer_load_dwordx4 v10, s[8:11], s16 offen lds
    s_add_u32 m0, s29, 33792
    s_nop 0
    buffer_load_dwordx4 v10, s[8:11], s30 offen lds
    s_add_u32 m0, s29, 40960
    s_nop 0
    buffer_load_dwordx4 v11, s[96:99], s17 offen lds
    s_add_u32 m0, s29, 41984
    s_nop 0
    buffer_load_dwordx4 v11, s[96:99], s31 offen lds
    s_add_u32 s16, s16, 64
    s_add_u32 s17, s17, 64
    s_add_u32 s30, s30, 64
    s_add_u32 s31, s31, 64
    v_and_b32 v3, 31, v2
    v_lshrrev_b32 v4, 5, v2
    v_bfe_u32 v5, v2, 2, 2
    s_and_b32 s4, s7, 1
    s_lshr_b32 s5, s7, 1
    s_lshr_b32 s26, s26, 1
    s_lshl_b32 s24, s4, 12
    s_add_u32 s24, s24, s26
    s_lshl_b32 s25, s5, 12
    s_sub_u32 s19, 8192, s26
    s_add_u32 s25, s25, s19
    v_or_b32 v6, 0, v4
    v_xor_b32 v6, v6, v5
    v_lshlrev_b32 v6, 4, v6
    v_lshl_add_u32 v6, v3, 6, v6
    v_add_u32 v16, s24, v6
    v_add_u32 v20, s25, v6
    v_or_b32 v6, 2, v4
    v_xor_b32 v6, v6, v5
    v_lshlrev_b32 v6, 4, v6
    v_lshl_add_u32 v6, v3, 6, v6
    v_add_u32 v17, s24, v6
    v_add_u32 v21, s25, v6
    v_mov_b32 v64, 0
    v_mov_b32 v65, 0
    v_mov_b32 v66, 0
    v_mov_b32 v67, 0
    v_mov_b32 v68, 0
    v_mov_b32 v69, 0
    v_mov_b32 v70, 0
    v_mov_b32 v71, 0
    v_mov_b32 v72, 0
    v_mov_b32 v73, 0
    v_mov_b32 v74, 0
    v_mov_b32 v75, 0
    v_mov_b32 v76, 0
    v_mov_b32 v77, 0
    v_mov_b32 v78, 0
    v_mov_b32 v79, 0
    v_mov_b32 v80, 0
    v_mov_b32 v81, 0
    v_mov_b32 v82, 0
    v_mov_b32 v83, 0
    v_mov_b32 v84, 0
    v_mov_b32 v85, 0
    v_mov_b32 v86, 0
    v_mov_b32 v87, 0
    v_mov_b32 v88, 0
    v_mov_b32 v89, 0
    v_mov_b32 v90, 0
    v_mov_b32 v91, 0
    v_mov_b32 v92, 0
    v_mov_b32 v93, 0
    v_mov_b32 v94, 0
    v_mov_b32 v95, 0
    v_mov_b32 v96, 0
    v_mov_b32 v97, 0
    v_mov_b32 v98, 0
    v_mov_b32 v99, 0
    v_mov_b32 v100, 0
    v_mov_b32 v101, 0
    v_mov_b32 v102, 0
    v_mov_b32 v103, 0
    v_mov_b32 v104, 0
    v_mov_b32 v105, 0
    v_mov_b32 v106, 0
    v_mov_b32 v107, 0
    v_mov_b32 v108, 0
    v_mov_b32 v109, 0
    v_mov_b32 v110, 0
    v_mov_b32 v111, 0
    v_mov_b32 v112, 0
    v_mov_b32 v113, 0
    v_mov_b32 v114, 0
    v_mov_b32 v115, 0
    v_mov_b32 v116, 0
    v_mov_b32 v117, 0
    v_mov_b32 v118, 0
    v_mov_b32 v119, 0
    v_mov_b32 v120, 0
    v_mov_b32 v121, 0
    v_mov_b32 v122, 0
    v_mov_b32 v123, 0
    v_mov_b32 v124, 0
    v_mov_b32 v125, 0
    v_mov_b32 v126, 0
    v_mov_b32 v127, 0
    s_cmp_eq_u32 s23, 0
    s_cbranch_scc1 g2_tail
g2_loop:
    s_waitcnt vmcnt(8)
    s_barrier
    ds_read_b128 v[32:35], v16 offset:0
    ds_read_b128 v[36:39], v16 offset:2048
    ds_read_b128 v[40:43], v20 offset:0
    ds_read_b128 v[44:47], v20 offset:2048
    ds_read_b128 v[48:51], v17 offset:0
    ds_read_b128 v[52:55], v17 offset:2048
    ds_read_b128 v[56:59], v21 offset:0
    ds_read_b128 v[60:63], v21 offset:2048
    s_add_u32 m0, s29, 49152
    s_nop 0
    buffer_load_dwordx4 v10, s[8:11], s16 offen lds
    s_add_u32 m0, s29, 50176
    s_nop 0
    buffer_load_dwordx4 v10, s[8:11], s30 offen lds
    s_waitcnt lgkmcnt(4)
    v_mfma_f32_32x32x16_bf16 v[64:79], v[32:35], v[40:43], v[64:79]
    s_add_u32 m0, s29, 57344
    s_nop 0
    buffer_load_dwordx4 v11, s[96:99], s17 offen lds
    v_mfma_f32_32x32x16_bf16 v[80:95], v[32:35], v[44:47], v[80:95]
    s_add_u32 m0, s29, 58368
    s_nop 0
    buffer_load_dwordx4 v11, s[96:99], s31 offen lds
    v_mfma_f32_32x32x16_bf16 v[96:111], v[36:39], v[40:43], v[96:111]
    v_mfma_f32_32x32x16_bf16 v[112:127], v[36:39], v[44:47], v[112:127]
    s_waitcnt lgkmcnt(0)
    v_mfma_f32_32x32x16_bf16 v[64:79], v[48:51], v[56:59], v[64:79]
    v_mfma_f32_32x32x16_bf16 v[80:95], v[48:51], v[60:63], v[80:95]
    v_mfma_f32_32x32x16_bf16 v[96:111], v[52:55], v[56:59], v[96:111]
    v_mfma_f32_32x32x16_bf16 v[112:127], v[52:55], v[60:63], v[112:127]
    s_add_u32 s16, s16, 64
    s_add_u32 s17, s17, 64
    s_add_u32 s30, s30, 64
    s_add_u32 s31, s31, 64
    s_waitcnt vmcnt(8)
    s_barrier
    ds_read_b128 v[32:35], v16 offset:16384
    ds_read_b128 v[36:39], v16 offset:18432
    ds_read_b128 v[40:43], v20 offset:16384
    ds_read_b128 v[44:47], v20 offset:18432
    ds_read_b128 v[48:51], v17 offset:16384
    ds_read_b128 v[52:55], v17 offset:18432
    ds_read_b128 v[56:59], v21 offset:16384
    ds_read_b128 v[60:63], v21 offset:18432
    s_add_u32 m0, s29, 0
    s_nop 0
    buffer_load_dwordx4 v10, s[8:11], s16 offen lds
    s_add_u32 m0, s29, 1024
    s_nop 0
    buffer_load_dwordx4 v10, s[8:11], s30 offen lds
    s_waitcnt lgkmcnt(4)
    v_mfma_f32_32x32x16_bf16 v[64:79], v[32:35], v[40:43], v[64:79]
    s_add_u32 m0, s29, 8192
    s_nop 0
    buffer_load_dwordx4 v11, s[96:99], s17 offen lds
    v_mfma_f32_32x32x16_bf16 v[80:95], v[32:35], v[44:47], v[80:95]
    s_add_u32 m0, s29, 9216
    s_nop 0
    buffer_load_dwordx4 v11, s[96:99], s31 offen lds
    v_mfma_f32_32x32x16_bf16 v[96:111], v[36:39], v[40:43], v[96:111]
    v_mfma_f32_32x32x16_bf16 v[112:127], v[36:39], v[44:47], v[112:127]
    s_waitcnt lgkmcnt(0)
    v_mfma_f32_32x32x16_bf16 v[64:79], v[48:51], v[56:59], v[64:79]
    v_mfma_f32_32x32x16_bf16 v[80:95], v[48:51], v[60:63], v[80:95]
    v_mfma_f32_32x32x16_bf16 v[96:111], v[52:55], v[56:59], v[96:111]
    v_mfma_f32_32x32x16_bf16 v[112:127], v[52:55], v[60:63], v[112:127]
    s_add_u32 s16, s16, 64
    s_add_u32 s17, s17, 64
    s_add_u32 s30, s30, 64
    s_add_u32 s31, s31, 64
    s_waitcnt vmcnt(8)
    s_barrier
    ds_read_b128 v[32:35], v16 offset:32768
    ds_read_b128 v[36:39], v16 offset:34816
    ds_read_b128 v[40:43], v20 offset:32768
    ds_read_b128 v[44:47], v20 offset:34816
    ds_read_b128 v[48:51], v17 offset:32768
    ds_read_b128 v[52:55], v17 offset:34816
    ds_read_b128 v[56:59], v21 offset:32768
    ds_read_b128 v[60:63], v21 offset:34816
    s_add_u32 m0, s29, 16384
    s_nop 0
    buffer_load_dwordx4 v10, s[8:11], s16 offen lds
    s_add_u32 m0, s29, 17408
    s_nop 0
    buffer_load_dwordx4 v10, s[8:11], s30 offen lds
    s_waitcnt lgkmcnt(4)
    v_mfma_f32_32x32x16_bf16 v[64:79], v[32:35], v[40:43], v[64:79]
    s_add_u32 m0, s29, 24576
    s_nop 0
    buffer_load_dwordx4 v11, s[96:99], s17 offen lds
    v_mfma_f32_32x32x16_bf16 v[80:95], v[32:35], v[44:47], v[80:95]
    s_add_u32 m0, s29, 25600
    s_nop 0
    buffer_load_dwordx4 v11, s[96:99], s31 offen lds
    v_mfma_f32_32x32x16_bf16 v[96:111], v[36:39], v[40:43], v[96:111]
    v_mfma_f32_32x32x16_bf16 v[112:127], v[36:39], v[44:47], v[112:127]
    s_waitcnt lgkmcnt(0)
    v_mfma_f32_32x32x16_bf16 v[64:79], v[48:51], v[56:59], v[64:79]
    v_mfma_f32_32x32x16_bf16 v[80:95], v[48:51], v[60:63], v[80:95]
    v_mfma_f32_32x32x16_bf16 v[96:111], v[52:55], v[56:59], v[96:111]
    v_mfma_f32_32x32x16_bf16 v[112:127], v[52:55], v[60:63], v[112:127]
    s_add_u32 s16, s16, 64
    s_add_u32 s17, s17, 64
    s_add_u32 s30, s30, 64
    s_add_u32 s31, s31, 64
    s_waitcnt vmcnt(8)
    s_barrier
    ds_read_b128 v[32:35], v16 offset:49152
    ds_read_b128 v[36:39], v16 offset:51200
    ds_read_b128 v[40:43], v20 offset:49152
    ds_read_b128 v[44:47], v20 offset:51200
    ds_read_b128 v[48:51], v17 offset:49152
    ds_read_b128 v[52:55], v17 offset:51200
    ds_read_b128 v[56:59], v21 offset:49152
    ds_read_b128 v[60:63], v21 offset:51200
    s_add_u32 m0, s29, 32768
    s_nop 0
    buffer_load_dwordx4 v10, s[8:11], s16 offen lds
    s_add_u32 m0, s29, 33792
    s_nop 0
    buffer_load_dwordx4 v10, s[8:11], s30 offen lds
    s_waitcnt lgkmcnt(4)
    v_mfma_f32_32x32x16_bf16 v[64:79], v[32:35], v[40:43], v[64:79]
    s_add_u32 m0, s29, 40960
    s_nop 0
    buffer_load_dwordx4 v11, s[96:99], s17 offen lds
    v_mfma_f32_32x32x16_bf16 v[80:95], v[32:35], v[44:47], v[80:95]
    s_add_u32 m0, s29, 41984
    s_nop 0
    buffer_load_dwordx4 v11, s[96:99], s31 offen lds
    v_mfma_f32_32x32x16_bf16 v[96:111], v[36:39], v[40:43], v[96:111]
    v_mfma_f32_32x32x16_bf16 v[112:127], v[36:39], v[44:47], v[112:127]
    s_waitcnt lgkmcnt(0)
    v_mfma_f32_32x32x16_bf16 v[64:79], v[48:51], v[56:59], v[64:79]
    v_mfma_f32_32x32x16_bf16 v[80:95], v[48:51], v[60:63], v[80:95]
    v_mfma_f32_32x32x16_bf16 v[96:111], v[52:55], v[56:59], v[96:111]
    v_mfma_f32_32x32x16_bf16 v[112:127], v[52:55], v[60:63], v[112:127]
    s_add_u32 s16, s16, 64
    s_add_u32 s17, s17, 64
    s_add_u32 s30, s30, 64
    s_add_u32 s31, s31, 64
    s_sub_u32 s23, s23, 1
    s_cmp_lg_u32 s23, 0
    s_cbranch_scc1 g2_loop
g2_tail:
    s_waitcnt vmcnt(8)
    s_barrier
    ds_read_b128 v[32:35], v16 offset:0
    ds_read_b128 v[36:39], v16 offset:2048
    ds_read_b128 v[40:43], v20 offset:0
    ds_read_b128 v[44:47], v20 offset:2048
    ds_read_b128 v[48:51], v17 offset:0
    ds_read_b128 v[52:55], v17 offset:2048
    ds_read_b128 v[56:59], v21 offset:0
    ds_read_b128 v[60:63], v21 offset:2048
    s_add_u32 m0, s29, 49152
    s_nop 0
    buffer_load_dwordx4 v10, s[8:11], s16 offen lds
    s_add_u32 m0, s29, 50176
    s_nop 0
    buffer_load_dwordx4 v10, s[8:11], s30 offen lds
    s_waitcnt lgkmcnt(4)
    v_mfma_f32_32x32x16_bf16 v[64:79], v[32:35], v[40:43], v[64:79]
    s_add_u32 m0, s29, 57344
    s_nop 0
    buffer_load_dwordx4 v11, s[96:99], s17 offen lds
    v_mfma_f32_32x32x16_bf16 v[80:95], v[32:35], v[44:47], v[80:95]
    s_add_u32 m0, s29, 58368
    s_nop 0
    buffer_load_dwordx4 v11, s[96:99], s31 offen lds
    v_mfma_f32_32x32x16_bf16 v[96:111], v[36:39], v[40:43], v[96:111]
    v_mfma_f32_32x32x16_bf16 v[112:127], v[36:39], v[44:47], v[112:127]
    s_waitcnt lgkmcnt(0)
    v_mfma_f32_32x32x16_bf16 v[64:79], v[48:51], v[56:59], v[64:79]
    v_mfma_f32_32x32x16_bf16 v[80:95], v[48:51], v[60:63], v[80:95]
    v_mfma_f32_32x32x16_bf16 v[96:111], v[52:55], v[56:59], v[96:111]
    v_mfma_f32_32x32x16_bf16 v[112:127], v[52:55], v[60:63], v[112:127]
    s_add_u32 s16, s16, 64
    s_add_u32 s17, s17, 64
    s_add_u32 s30, s30, 64
    s_add_u32 s31, s31, 64
    s_waitcnt vmcnt(8)
    s_barrier
    ds_read_b128 v[32:35], v16 offset:16384
    ds_read_b128 v[36:39], v16 offset:18432
    ds_read_b128 v[40:43], v20 offset:16384
    ds_read_b128 v[44:47], v20 offset:18432
    ds_read_b128 v[48:51], v17 offset:16384
    ds_read_b128 v[52:55], v17 offset:18432
    ds_read_b128 v[56:59], v21 offset:16384
    ds_read_b128 v[60:63], v21 offset:18432
    s_waitcnt lgkmcnt(4)
    v_mfma_f32_32x32x16_bf16 v[64:79], v[32:35], v[40:43], v[64:79]
    v_mfma_f32_32x32x16_bf16 v[80:95], v[32:35], v[44:47], v[80:95]
    v_mfma_f32_32x32x16_bf16 v[96:111], v[36:39], v[40:43], v[96:111]
    v_mfma_f32_32x32x16_bf16 v[112:127], v[36:39], v[44:47], v[112:127]
    s_waitcnt lgkmcnt(0)
    v_mfma_f32_32x32x16_bf16 v[64:79], v[48:51], v[56:59], v[64:79]
    v_mfma_f32_32x32x16_bf16 v[80:95], v[48:51], v[60:63], v[80:95]
    v_mfma_f32_32x32x16_bf16 v[96:111], v[52:55], v[56:59], v[96:111]
    v_mfma_f32_32x32x16_bf16 v[112:127], v[52:55], v[60:63], v[112:127]
    s_waitcnt vmcnt(4)
    s_barrier
    ds_read_b128 v[32:35], v16 offset:32768
    ds_read_b128 v[36:39], v16 offset:34816
    ds_read_b128 v[40:43], v20 offset:32768
    ds_read_b128 v[44:47], v20 offset:34816
    ds_read_b128 v[48:51], v17 offset:32768
    ds_read_b128 v[52:55], v17 offset:34816
    ds_read_b128 v[56:59], v21 offset:32768
    ds_read_b128 v[60:63], v21 offset:34816
    s_waitcnt lgkmcnt(4)
    v_mfma_f32_32x32x16_bf16 v[64:79], v[32:35], v[40:43], v[64:79]
    v_mfma_f32_32x32x16_bf16 v[80:95], v[32:35], v[44:47], v[80:95]
    v_mfma_f32_32x32x16_bf16 v[96:111], v[36:39], v[40:43], v[96:111]
    v_mfma_f32_32x32x16_bf16 v[112:127], v[36:39], v[44:47], v[112:127]
    s_waitcnt lgkmcnt(0)
    v_mfma_f32_32x32x16_bf16 v[64:79], v[48:51], v[56:59], v[64:79]
    v_mfma_f32_32x32x16_bf16 v[80:95], v[48:51], v[60:63], v[80:95]
    v_mfma_f32_32x32x16_bf16 v[96:111], v[52:55], v[56:59], v[96:111]
    v_mfma_f32_32x32x16_bf16 v[112:127], v[52:55], v[60:63], v[112:127]
    s_waitcnt vmcnt(0)
    s_barrier
    ds_read_b128 v[32:35], v16 offset:49152
    ds_read_b128 v[36:39], v16 offset:51200
    ds_read_b128 v[40:43], v20 offset:49152
    ds_read_b128 v[44:47], v20 offset:51200
    ds_read_b128 v[48:51], v17 offset:49152
    ds_read_b128 v[52:55], v17 offset:51200
    ds_read_b128 v[56:59], v21 offset:49152
    ds_read_b128 v[60:63], v21 offset:51200
    s_waitcnt lgkmcnt(4)
    v_mfma_f32_32x32x16_bf16 v[64:79], v[32:35], v[40:43], v[64:79]
    v_mfma_f32_32x32x16_bf16 v[80:95], v[32:35], v[44:47], v[80:95]
    v_mfma_f32_32x32x16_bf16 v[96:111], v[36:39], v[40:43], v[96:111]
    v_mfma_f32_32x32x16_bf16 v[112:127], v[36:39], v[44:47], v[112:127]
    s_waitcnt lgkmcnt(0)
    v_mfma_f32_32x32x16_bf16 v[64:79], v[48:51], v[56:59], v[64:79]
    v_mfma_f32_32x32x16_bf16 v[80:95], v[48:51], v[60:63], v[80:95]
    v_mfma_f32_32x32x16_bf16 v[96:111], v[52:55], v[56:59], v[96:111]
    v_mfma_f32_32x32x16_bf16 v[112:127], v[52:55], v[60:63], v[112:127]
    s_mul_i32 s19, s7, 9216
    v_mul_u32_u24 v6, 144, v3
    v_lshl_add_u32 v6, v4, 3, v6
    v_add_u32 v6, s19, v6
    v_lshrrev_b32 v7, 3, v2
    v_and_b32 v8, 7, v2
    v_mul_u32_u24 v9, 144, v7
    v_lshl_add_u32 v9, v8, 4, v9
    v_add_u32 v9, s19, v9
    s_lshl_b32 s19, s5, 6
    v_add_u32 v7, s19, v7
    v_mul_lo_u32 v7, v7, s22
    v_lshrrev_b32 v10, 2, v8
    v_mul_lo_u32 v10, v10, s28
    v_add_u32 v7, v7, v10
    v_and_b32 v8, 3, v8
    v_lshl_add_u32 v7, v8, 4, v7
    s_mul_i32 s19, s4, s27
    s_add_u32 s18, s18, s19
    s_lshl_b32 s19, s22, 3
    s_barrier
    s_nop 7
    v_cvt_pk_bf16_f32 v64, v64, v65
    v_cvt_pk_bf16_f32 v65, v66, v67
    ds_write_b64 v6, v[64:65] offset:0
    v_cvt_pk_bf16_f32 v68, v68, v69
    v_cvt_pk_bf16_f32 v69, v70, v71
    ds_write_b64 v6, v[68:69] offset:16
    v_cvt_pk_bf16_f32 v72, v72, v73
    v_cvt_pk_bf16_f32 v73, v74, v75
    ds_write_b64 v6, v[72:73] offset:32
    v_cvt_pk_bf16_f32 v76, v76, v77
    v_cvt_pk_bf16_f32 v77, v78, v79
    ds_write_b64 v6, v[76:77] offset:48
    v_cvt_pk_bf16_f32 v80, v80, v81
    v_cvt_pk_bf16_f32 v81, v82, v83
    ds_write_b64 v6, v[80:81] offset:4608
    v_cvt_pk_bf16_f32 v84, v84, v85
    v_cvt_pk_bf16_f32 v85, v86, v87
    ds_write_b64 v6, v[84:85] offset:4624
    v_cvt_pk_bf16_f32 v88, v88, v89
    v_cvt_pk_bf16_f32 v89, v90, v91
    ds_write_b64 v6, v[88:89] offset:4640
    v_cvt_pk_bf16_f32 v92, v92, v93
    v_cvt_pk_bf16_f32 v93, v94, v95
    ds_write_b64 v6, v[92:93] offset:4656
    v_cvt_pk_bf16_f32 v96, v96, v97
    v_cvt_pk_bf16_f32 v97, v98, v99
    ds_write_b64 v6, v[96:97] offset:64
    v_cvt_pk_bf16_f32 v100, v100, v101
    v_cvt_pk_bf16_f32 v101, v102, v103
    ds_write_b64 v6, v[100:101] offset:80
    v_cvt_pk_bf16_f32 v104, v104, v105
    v_cvt_pk_bf16_f32 v105, v106, v107
    ds_write_b64 v6, v[104:105] offset:96
    v_cvt_pk_bf16_f32 v108, v108, v109
    v_cvt_pk_bf16_f32 v109, v110, v111
    ds_write_b64 v6, v[108:109] offset:112
    v_cvt_pk_bf16_f32 v112, v112, v113
    v_cvt_pk_bf16_f32 v113, v114, v115
    ds_write_b64 v6, v[112:113] offset:4672
    v_cvt_pk_bf16_f32 v116, v116, v117
    v_cvt_pk_bf16_f32 v117, v118, v119
    ds_write_b64 v6, v[116:117] offset:4688
    v_cvt_pk_bf16_f32 v120, v120, v121
    v_cvt_pk_bf16_f32 v121, v122, v123
    ds_write_b64 v6, v[120:121] offset:4704
    v_cvt_pk_bf16_f32 v124, v124, v125
    v_cvt_pk_bf16_f32 v125, v126, v127
    ds_write_b64 v6, v[124:125] offset:4720
    s_waitcnt lgkmcnt(0)
    ds_read_b128 v[32:35], v9 offset:0
    ds_read_b128 v[36:39], v9 offset:1152
    ds_read_b128 v[40:43], v9 offset:2304
    ds_read_b128 v[44:47], v9 offset:3456
    ds_read_b128 v[48:51], v9 offset:4608
    ds_read_b128 v[52:55], v9 offset:5760
    ds_read_b128 v[56:59], v9 offset:6912
    ds_read_b128 v[60:63], v9 offset:8064
    s_waitcnt lgkmcnt(7)
    buffer_store_dwordx4 v[32:35], v7, s[12:15], s18 offen
    s_add_u32 s18, s18, s19
    s_waitcnt lgkmcnt(6)
    buffer_store_dwordx4 v[36:39], v7, s[12:15], s18 offen
    s_add_u32 s18, s18, s19
    s_waitcnt lgkmcnt(5)
    buffer_store_dwordx4 v[40:43], v7, s[12:15], s18 offen
    s_add_u32 s18, s18, s19
    s_waitcnt lgkmcnt(4)
    buffer_store_dwordx4 v[44:47], v7, s[12:15], s18 offen
    s_add_u32 s18, s18, s19
    s_waitcnt lgkmcnt(3)
    buffer_store_dwordx4 v[48:51], v7, s[12:15], s18 offen
    s_add_u32 s18, s18, s19
    s_waitcnt lgkmcnt(2)
    buffer_store_dwordx4 v[52:55], v7, s[12:15], s18 offen
    s_add_u32 s18, s18, s19
    s_waitcnt lgkmcnt(1)
    buffer_store_dwordx4 v[56:59], v7, s[12:15], s18 offen
    s_add_u32 s18, s18, s19
    s_waitcnt lgkmcnt(0)
    buffer_store_dwordx4 v[60:63], v7, s[12:15], s18 offen
g2_end:
    s_endpgm
.section .rodata,"a"
.p2align 6
.amdhsa_kernel tr_kernel
  .amdhsa_next_free_vgpr 32
  .amdhsa_next_free_sgpr 102
  .amdhsa_accum_offset 32
  .amdhsa_group_segment_fixed_size 0
  .amdhsa_kernarg_size 104
  .amdhsa_user_sgpr_count 2
  .amdhsa_user_sgpr_kernarg_segment_ptr 1
  .amdhsa_system_sgpr_workgroup_id_x 1
.end_amdhsa_kernel
.p2align 6
.amdhsa_kernel mega_kernel
  .amdhsa_next_free_vgpr 512
  .amdhsa_next_free_sgpr 102
  .amdhsa_accum_offset 256
  .amdhsa_group_segment_fixed_size 0
  .amdhsa_kernarg_size 104
  .amdhsa_user_sgpr_count 2
  .amdhsa_user_sgpr_kernarg_segment_ptr 1
  .amdhsa_system_sgpr_workgroup_id_x 1
.end_amdhsa_kernel
```
